```python
import torch

def _softmax(x, axis=-1):
    return torch.softmax(x, dim=axis)

def _gelu(x):
    return torch.nn.functional.gelu(x, approximate='tanh')

def _silu(x):
    return torch.nn.functional.silu(x)

def _sigmoid(x):
    return torch.sigmoid(x)

def _layernorm(x, axis=-1, eps=1e-05):
    m = x.mean(dim=axis, keepdim=True)
    v = x.var(dim=axis, keepdim=True, unbiased=False)
    return (x - m) / torch.sqrt(v + eps)

def _scatter_add(tgt, idx, src, axis=0):
    return tgt.clone().index_add_(axis, idx, src)

def _segment_sum(src, seg, n):
    out = torch.zeros((n,) + src.shape[1:], dtype=src.dtype)
    return out.index_add_(0, seg, src)

def _pad(x, pw):
    flat = tuple((v for pair in reversed(pw) for v in pair))
    return torch.nn.functional.pad(x, flat)
kernel_name = 'gather_scatter__molecular_angular_painn__graph'

def setup_inputs():

    _w = lambda a: (lambda t: t.to(torch.bfloat16) if t.is_floating_point() else t)(torch.as_tensor(a))
    N, deg, D = (12500, 32, 128)
    n_rbf = max(4, 4)
    E = N * deg
    cutoff = 5.0
    freqs = (torch.arange(1, n_rbf + 1) * torch.pi / cutoff).to(float)
    return {'sv': _w((lambda *s: torch.randn(*s, dtype=torch.bfloat16) * 0.4)(N, 4, D) * 0.3), 'pos': _w((lambda *s: torch.randn(*s, dtype=torch.bfloat16) * 3.2)(N, 3) * 1.2), 'src': _w((lambda lo, hi, *s: torch.randint(lo, hi, s))(0, N, E).to(torch.int64)), 'dst': _w((lambda lo, hi, *s: torch.randint(lo, hi, s))(0, N, E).to(torch.int64)), 'freqs': _w(freqs), 'w_phi1': _w((lambda *s: torch.randn(*s, dtype=torch.bfloat16) * 3.2)(D, D) / D ** 0.5), 'w_phi2': _w((lambda *s: torch.randn(*s, dtype=torch.bfloat16) * 3.2)(D, 3 * D) / D ** 0.5), 'w_rbf': _w((lambda *s: torch.randn(*s, dtype=torch.bfloat16) * 3.2)(n_rbf, 3 * D) / n_rbf ** 0.5)}

def reference(sv, pos, src, dst, freqs, w_phi1, w_phi2, w_rbf):
    N, _, D = sv.shape
    E = src.shape[0]
    PI, cutoff = (3.141592653589793, 5.0)
    s, v = (sv[:, 0, :].clone(), sv[:, 1:, :].clone())
    r_vec = pos[src] - pos[dst]
    d = torch.sqrt((r_vec * r_vec).sum(-1) + 1e-08)
    r_hat = r_vec / d[:, None]
    rbf = torch.sin(d[:, None] * freqs[None, :]) / d[:, None]
    fcut = 0.5 * (torch.cos(PI * d / cutoff) + 1.0)
    fcut = torch.where(d < cutoff, fcut, 0.0 * d)
    Wf = rbf @ w_rbf * fcut[:, None]
    phi = (_silu(s @ w_phi1) @ w_phi2)[src]
    m = phi * Wf
    m_s, m_vv, m_vr = (m[:, :D].clone(), m[:, D:2 * D].clone(), m[:, 2 * D:].clone())
    ds = _segment_sum(m_s, dst, N)
    dv_e = m_vv[:, None, :] * v[src] + m_vr[:, None, :] * r_hat[:, :, None]
    dv = _segment_sum(dv_e.reshape(E, 3 * D), dst, N).reshape(N, 3, D)
    return sv + torch.concatenate([ds[:, None, :], dv], axis=1)
```

```asm
; @launch kernel=painn_k1_kernel grid=(256,1,1) block=(1024,1,1) lds=148480
; @launch kernel=painn_k2_kernel grid=(768,1,1) block=(256,1,1) lds=43136
.amdgcn_target "amdgcn-amd-amdhsa--gfx950"
.text
.globl painn_k1_kernel
.p2align 8
.type painn_k1_kernel,@function
painn_k1_kernel:
  s_cmp_ge_u32 s2, 256
  s_cbranch_scc1 K1_END
  s_load_dwordx16 s[16:31], s[0:1], 0
  s_load_dwordx2 s[32:33], s[0:1], 80
  s_mov_b32 s58, 0xffff0000
  v_lshrrev_b32 v1, 6, v0
  s_nop 0
  v_readfirstlane_b32 s66, v1
  s_cmp_ge_u32 s2, 60
  s_cbranch_scc1 K1_MLP
  s_waitcnt lgkmcnt(0)
  s_load_dwordx2 s[60:61], s[24:25], 0
  s_mov_b32 s36, s18
  s_mov_b32 s37, s19
  s_mov_b32 s38, 75000
  s_mov_b32 s39, 0x20000
  s_mov_b32 s40, s20
  s_mov_b32 s41, s21
  s_mov_b32 s42, 1600000
  s_mov_b32 s43, 0x20000
  s_mov_b32 s44, s22
  s_mov_b32 s45, s23
  s_mov_b32 s46, 1600000
  s_mov_b32 s47, 0x20000
  s_cmp_lg_u32 s2, 0
  s_cselect_b32 s69, 99, s66
  s_cmp_ge_u32 s69, 12
  s_cbranch_scc1 K1_NOBW
  s_mov_b32 s8, s30
  s_mov_b32 s9, s31
  s_mov_b32 s10, 3072
  s_mov_b32 s11, 0x20000
  v_and_b32 v77, 7, v0
  v_bfe_u32 v78, v0, 5, 1
  v_bfe_u32 v79, v0, 4, 1
  v_lshl_or_b32 v78, v79, 1, v78
  v_lshl_add_u32 v77, v77, 3, v78
  v_lshlrev_b32 v77, 1, v77
  s_cmp_ge_u32 s66, 6
  s_cselect_b32 s6, 6, 0
  s_cselect_b32 s7, 128, 0
  s_sub_u32 s6, s66, s6
  s_lshr_b32 s4, s6, 1
  s_lshl_b32 s4, s4, 8
  s_and_b32 s5, s6, 1
  s_lshl_b32 s5, s5, 3
  s_add_u32 s4, s4, s5
  s_add_u32 s4, s4, s7
  buffer_load_ushort v88, v77, s[8:11], s4 offen offset:0
  buffer_load_ushort v89, v77, s[8:11], s4 offen offset:768
  buffer_load_ushort v90, v77, s[8:11], s4 offen offset:1536
  buffer_load_ushort v91, v77, s[8:11], s4 offen offset:2304
K1_NOBW:
  v_mul_u32_u24 v1, 12, v0
  s_mov_b32 s4, 0
  buffer_load_dwordx3 v[20:22], v1, s[36:39], s4 offen
  s_mov_b32 s4, 12288
  buffer_load_dwordx3 v[24:26], v1, s[36:39], s4 offen
  s_mov_b32 s4, 24576
  buffer_load_dwordx3 v[28:30], v1, s[36:39], s4 offen
  s_mov_b32 s4, 36864
  buffer_load_dwordx3 v[32:34], v1, s[36:39], s4 offen
  s_mov_b32 s4, 49152
  buffer_load_dwordx3 v[36:38], v1, s[36:39], s4 offen
  s_mov_b32 s4, 61440
  buffer_load_dwordx3 v[40:42], v1, s[36:39], s4 offen
  s_mov_b32 s4, 73728
  buffer_load_dwordx3 v[44:46], v1, s[36:39], s4 offen
  s_barrier
  s_mul_i32 s56, s2, 6668
  s_lshl_b32 s3, s56, 2
  v_lshlrev_b32 v1, 4, v0
  v_add_u32 v76, s3, v1
  v_add_u32 v77, 16384, v76
  v_lshlrev_b32 v1, 2, v0
  buffer_load_dwordx4 v[2:5], v76, s[40:43], 0 offen
  buffer_load_dwordx4 v[10:13], v76, s[44:47], 0 offen
  buffer_load_dwordx4 v[6:9], v77, s[40:43], 0 offen
  buffer_load_dwordx4 v[14:17], v77, s[44:47], 0 offen
  s_add_u32 s48, s32, 17039360
  s_addc_u32 s49, s33, 0
  s_mov_b32 s50, 262144
  s_mov_b32 s51, 0x20000
  s_sub_u32 s57, 400000, s56
  s_min_u32 s57, s57, 6668
  s_mul_i32 s3, s2, 213376
  s_add_u32 s3, s3, 17301504
  s_add_u32 s52, s32, s3
  s_addc_u32 s53, s33, 0
  s_mov_b32 s54, 213376
  s_mov_b32 s55, 0x20000
  v_mov_b32 v92, 0xffff0000
  v_mov_b32 v77, 0
  ds_write_b32 v1, v77 offset:0
  v_lshlrev_b32 v79, 4, v0
  v_add_u32 v79, 30976, v79
  v_add_u32 v80, 65536, v79
  s_waitcnt vmcnt(10)
  v_and_b32 v23, v92, v22
  v_alignbit_b32 v22, v22, v21, 16
  v_lshlrev_b32 v21, 16, v21
  ds_write_b128 v79, v[20:23] offset:0
  s_waitcnt vmcnt(9)
  v_and_b32 v27, v92, v26
  v_alignbit_b32 v26, v26, v25, 16
  v_lshlrev_b32 v25, 16, v25
  ds_write_b128 v79, v[24:27] offset:16384
  s_waitcnt vmcnt(8)
  v_and_b32 v31, v92, v30
  v_alignbit_b32 v30, v30, v29, 16
  v_lshlrev_b32 v29, 16, v29
  ds_write_b128 v79, v[28:31] offset:32768
  s_waitcnt vmcnt(7)
  v_and_b32 v35, v92, v34
  v_alignbit_b32 v34, v34, v33, 16
  v_lshlrev_b32 v33, 16, v33
  ds_write_b128 v79, v[32:35] offset:49152
  s_waitcnt vmcnt(6)
  v_and_b32 v39, v92, v38
  v_alignbit_b32 v38, v38, v37, 16
  v_lshlrev_b32 v37, 16, v37
  ds_write_b128 v80, v[36:39] offset:0
  s_waitcnt vmcnt(5)
  v_and_b32 v43, v92, v42
  v_alignbit_b32 v42, v42, v41, 16
  v_lshlrev_b32 v41, 16, v41
  ds_write_b128 v80, v[40:43] offset:16384
  s_waitcnt vmcnt(4)
  v_and_b32 v47, v92, v46
  v_alignbit_b32 v46, v46, v45, 16
  v_lshlrev_b32 v45, 16, v45
  ds_write_b128 v80, v[44:47] offset:32768
  s_cmp_ge_u32 s69, 12
  s_cbranch_scc1 K1_NOBW2
  s_add_u32 s12, s32, 16973824
  s_addc_u32 s13, s33, 0
  s_mov_b32 s14, 12288
  s_mov_b32 s15, 0x20000
  v_lshlrev_b32 v77, 4, v0
  v_and_b32 v78, 8, v0
  v_cmp_eq_u32 vcc, 0, v78
  v_lshl_or_b32 v88, v89, 16, v88
  v_lshl_or_b32 v89, v91, 16, v90
  v_cndmask_b32 v90, v88, 0, vcc
  v_cndmask_b32 v91, v89, 0, vcc
  v_cndmask_b32 v88, 0, v88, vcc
  v_cndmask_b32 v89, 0, v89, vcc
  buffer_store_dwordx4 v[88:91], v77, s[12:15], 0 offen
K1_NOBW2:
  s_waitcnt lgkmcnt(0)
  s_barrier
  s_lshl_b32 s62, s60, 16
  s_and_b32 s63, s60, s58
  s_lshl_b32 s64, s61, 16
  s_and_b32 s65, s61, s58
  s_cmp_ge_u32 s66, 6
  s_cbranch_scc1 K1_NOMSK
  s_cmp_ge_u32 s66, 3
  s_cselect_b32 s4, 60, 0
  s_cselect_b32 s5, 3, 0
  s_add_u32 s4, s4, s2
  s_sub_u32 s5, s66, s5
  s_cmp_ge_u32 s4, 96
  s_cbranch_scc1 K1_NOMSK
  v_and_b32 v76, 63, v0
  s_lshl_b32 s6, s5, 6
  v_add_u32 v80, s6, v76
  s_mul_i32 s6, s4, 131
  v_add_u32 v81, s6, v80
  v_lshlrev_b32 v77, 3, v81
  ds_read_b32 v78, v77 offset:30976
  s_mov_b32 s3, 12500
  v_cmp_gt_u32 s[6:7], s3, v81
  v_cmp_gt_u32 vcc, 131, v80
  s_and_b64 s[6:7], s[6:7], vcc
  s_add_u32 s12, s32, 16990208
  s_addc_u32 s13, s33, 0
  s_mov_b32 s14, 32768
  s_mov_b32 s15, 0x20000
  s_waitcnt lgkmcnt(0)
  v_lshrrev_b32 v77, 31, v78
  v_lshlrev_b32 v78, 16, v78
  v_alignbit_b32 v78, v77, v78, 31
  v_cmp_eq_u32 vcc, 0, v78
  s_and_b64 vcc, vcc, s[6:7]
  s_nop 0
  v_writelane_b32 v80, vcc_lo, 0
  v_writelane_b32 v81, vcc_hi, 0
  v_cmp_eq_u32 vcc, 1, v78
  s_and_b64 vcc, vcc, s[6:7]
  s_nop 0
  v_writelane_b32 v80, vcc_lo, 1
  v_writelane_b32 v81, vcc_hi, 1
  v_cmp_eq_u32 vcc, 2, v78
  s_and_b64 vcc, vcc, s[6:7]
  s_nop 0
  v_writelane_b32 v80, vcc_lo, 2
  v_writelane_b32 v81, vcc_hi, 2
  v_cmp_eq_u32 vcc, 3, v78
  s_and_b64 vcc, vcc, s[6:7]
  s_nop 0
  v_writelane_b32 v80, vcc_lo, 3
  v_writelane_b32 v81, vcc_hi, 3
  s_lshl_b32 s4, s4, 7
  s_lshl_b32 s5, s5, 3
  s_add_u32 s4, s4, s5
  v_lshlrev_b32 v76, 5, v76
  v_add_u32 v76, s4, v76
  s_mov_b64 exec, 0xf
  buffer_store_dwordx2 v[80:81], v76, s[12:15], 0 offen
  s_mov_b64 exec, -1
K1_NOMSK:
  s_waitcnt vmcnt(0)
  v_lshlrev_b32 v76, 3, v2
  v_lshlrev_b32 v77, 3, v10
  ds_read_b64 v[20:21], v76 offset:30976
  ds_read_b64 v[22:23], v77 offset:30976
  v_lshlrev_b32 v76, 3, v3
  v_lshlrev_b32 v77, 3, v11
  ds_read_b64 v[24:25], v76 offset:30976
  ds_read_b64 v[26:27], v77 offset:30976
  v_lshlrev_b32 v76, 3, v4
  v_lshlrev_b32 v77, 3, v12
  ds_read_b64 v[28:29], v76 offset:30976
  ds_read_b64 v[30:31], v77 offset:30976
  v_lshlrev_b32 v76, 3, v5
  v_lshlrev_b32 v77, 3, v13
  ds_read_b64 v[32:33], v76 offset:30976
  ds_read_b64 v[34:35], v77 offset:30976
  v_lshlrev_b32 v76, 3, v6
  v_lshlrev_b32 v77, 3, v14
  ds_read_b64 v[36:37], v76 offset:30976
  ds_read_b64 v[38:39], v77 offset:30976
  v_lshlrev_b32 v76, 3, v7
  v_lshlrev_b32 v77, 3, v15
  ds_read_b64 v[40:41], v76 offset:30976
  ds_read_b64 v[42:43], v77 offset:30976
  v_lshlrev_b32 v76, 3, v8
  v_lshlrev_b32 v77, 3, v16
  ds_read_b64 v[44:45], v76 offset:30976
  ds_read_b64 v[46:47], v77 offset:30976
  v_lshlrev_b32 v76, 3, v9
  v_lshlrev_b32 v77, 3, v17
  ds_read_b64 v[48:49], v76 offset:30976
  ds_read_b64 v[50:51], v77 offset:30976
  s_mov_b32 s5, 1103757312
  s_mov_b32 s59, 8005
  v_mov_b32 v78, 0xffff
  v_lshl_or_b32 v52, v10, 16, v2
  v_mul_u32_u24 v60, s59, v10
  v_lshrrev_b32 v60, 20, v60
  s_waitcnt lgkmcnt(14)
  v_lshlrev_b32 v76, 16, v20
  v_lshlrev_b32 v77, 16, v22
  v_alignbit_b32 v60, v60, v22, 31
  v_and_b32 v20, v92, v20
  v_and_b32 v22, v92, v22
  v_sub_f32 v76, v76, v77
  v_sub_f32 v20, v20, v22
  v_alignbit_b32 v60, v60, v77, 31
  v_sub_f32 v21, v21, v23
  v_mul_f32 v76, v76, v76
  v_lshlrev_b32 v60, 2, v60
  v_fmac_f32 v76, v20, v20
  v_fmac_f32 v76, v21, v21
  v_cmp_gt_f32 s[70:71], s5, v76
  v_lshl_or_b32 v53, v11, 16, v3
  v_mul_u32_u24 v61, s59, v11
  v_lshrrev_b32 v61, 20, v61
  s_waitcnt lgkmcnt(12)
  v_lshlrev_b32 v76, 16, v24
  v_lshlrev_b32 v77, 16, v26
  v_alignbit_b32 v61, v61, v26, 31
  v_and_b32 v24, v92, v24
  v_and_b32 v26, v92, v26
  v_sub_f32 v76, v76, v77
  v_sub_f32 v24, v24, v26
  v_alignbit_b32 v61, v61, v77, 31
  v_sub_f32 v25, v25, v27
  v_mul_f32 v76, v76, v76
  v_lshlrev_b32 v61, 2, v61
  v_fmac_f32 v76, v24, v24
  v_fmac_f32 v76, v25, v25
  v_cmp_gt_f32 s[72:73], s5, v76
  v_lshl_or_b32 v54, v12, 16, v4
  v_mul_u32_u24 v62, s59, v12
  v_lshrrev_b32 v62, 20, v62
  s_waitcnt lgkmcnt(10)
  v_lshlrev_b32 v76, 16, v28
  v_lshlrev_b32 v77, 16, v30
  v_alignbit_b32 v62, v62, v30, 31
  v_and_b32 v28, v92, v28
  v_and_b32 v30, v92, v30
  v_sub_f32 v76, v76, v77
  v_sub_f32 v28, v28, v30
  v_alignbit_b32 v62, v62, v77, 31
  v_sub_f32 v29, v29, v31
  v_mul_f32 v76, v76, v76
  v_lshlrev_b32 v62, 2, v62
  v_fmac_f32 v76, v28, v28
  v_fmac_f32 v76, v29, v29
  v_cmp_gt_f32 s[74:75], s5, v76
  v_lshl_or_b32 v55, v13, 16, v5
  v_mul_u32_u24 v63, s59, v13
  v_lshrrev_b32 v63, 20, v63
  s_waitcnt lgkmcnt(8)
  v_lshlrev_b32 v76, 16, v32
  v_lshlrev_b32 v77, 16, v34
  v_alignbit_b32 v63, v63, v34, 31
  v_and_b32 v32, v92, v32
  v_and_b32 v34, v92, v34
  v_sub_f32 v76, v76, v77
  v_sub_f32 v32, v32, v34
  v_alignbit_b32 v63, v63, v77, 31
  v_sub_f32 v33, v33, v35
  v_mul_f32 v76, v76, v76
  v_lshlrev_b32 v63, 2, v63
  v_fmac_f32 v76, v32, v32
  v_fmac_f32 v76, v33, v33
  v_cmp_gt_f32 s[76:77], s5, v76
  v_lshl_or_b32 v56, v14, 16, v6
  v_mul_u32_u24 v64, s59, v14
  v_lshrrev_b32 v64, 20, v64
  s_waitcnt lgkmcnt(6)
  v_lshlrev_b32 v76, 16, v36
  v_lshlrev_b32 v77, 16, v38
  v_alignbit_b32 v64, v64, v38, 31
  v_and_b32 v36, v92, v36
  v_and_b32 v38, v92, v38
  v_sub_f32 v76, v76, v77
  v_sub_f32 v36, v36, v38
  v_alignbit_b32 v64, v64, v77, 31
  v_sub_f32 v37, v37, v39
  v_mul_f32 v76, v76, v76
  v_lshlrev_b32 v64, 2, v64
  v_fmac_f32 v76, v36, v36
  v_fmac_f32 v76, v37, v37
  v_cmp_gt_f32 s[78:79], s5, v76
  v_lshl_or_b32 v57, v15, 16, v7
  v_mul_u32_u24 v65, s59, v15
  v_lshrrev_b32 v65, 20, v65
  s_waitcnt lgkmcnt(4)
  v_lshlrev_b32 v76, 16, v40
  v_lshlrev_b32 v77, 16, v42
  v_alignbit_b32 v65, v65, v42, 31
  v_and_b32 v40, v92, v40
  v_and_b32 v42, v92, v42
  v_sub_f32 v76, v76, v77
  v_sub_f32 v40, v40, v42
  v_alignbit_b32 v65, v65, v77, 31
  v_sub_f32 v41, v41, v43
  v_mul_f32 v76, v76, v76
  v_lshlrev_b32 v65, 2, v65
  v_fmac_f32 v76, v40, v40
  v_fmac_f32 v76, v41, v41
  v_cmp_gt_f32 s[80:81], s5, v76
  v_lshl_or_b32 v58, v16, 16, v8
  v_mul_u32_u24 v66, s59, v16
  v_lshrrev_b32 v66, 20, v66
  s_waitcnt lgkmcnt(2)
  v_lshlrev_b32 v76, 16, v44
  v_lshlrev_b32 v77, 16, v46
  v_alignbit_b32 v66, v66, v46, 31
  v_and_b32 v44, v92, v44
  v_and_b32 v46, v92, v46
  v_sub_f32 v76, v76, v77
  v_sub_f32 v44, v44, v46
  v_alignbit_b32 v66, v66, v77, 31
  v_sub_f32 v45, v45, v47
  v_mul_f32 v76, v76, v76
  v_lshlrev_b32 v66, 2, v66
  v_fmac_f32 v76, v44, v44
  v_fmac_f32 v76, v45, v45
  v_cmp_gt_f32 s[82:83], s5, v76
  v_lshl_or_b32 v59, v17, 16, v9
  v_mul_u32_u24 v67, s59, v17
  v_lshrrev_b32 v67, 20, v67
  s_waitcnt lgkmcnt(0)
  v_lshlrev_b32 v76, 16, v48
  v_lshlrev_b32 v77, 16, v50
  v_alignbit_b32 v67, v67, v50, 31
  v_and_b32 v48, v92, v48
  v_and_b32 v50, v92, v50
  v_sub_f32 v76, v76, v77
  v_sub_f32 v48, v48, v50
  v_alignbit_b32 v67, v67, v77, 31
  v_sub_f32 v49, v49, v51
  v_mul_f32 v76, v76, v76
  v_lshlrev_b32 v67, 2, v67
  v_fmac_f32 v76, v48, v48
  v_fmac_f32 v76, v49, v49
  v_cmp_gt_f32 s[84:85], s5, v76
  v_lshlrev_b32 v1, 2, v0
  s_sub_u32 s4, s57, 4096
  v_cmp_gt_i32 vcc, s4, v1
  s_and_b64 s[78:79], s[78:79], vcc
  s_sub_u32 s4, s57, 4097
  v_cmp_gt_i32 vcc, s4, v1
  s_and_b64 s[80:81], s[80:81], vcc
  s_sub_u32 s4, s57, 4098
  v_cmp_gt_i32 vcc, s4, v1
  s_and_b64 s[82:83], s[82:83], vcc
  s_sub_u32 s4, s57, 4099
  v_cmp_gt_i32 vcc, s4, v1
  s_and_b64 s[84:85], s[84:85], vcc
  v_mov_b32 v76, 1
  s_mov_b64 exec, s[70:71]
  ds_add_rtn_u32 v68, v60, v76 offset:0
  s_mov_b64 exec, s[72:73]
  ds_add_rtn_u32 v69, v61, v76 offset:0
  s_mov_b64 exec, s[74:75]
  ds_add_rtn_u32 v70, v62, v76 offset:0
  s_mov_b64 exec, s[76:77]
  ds_add_rtn_u32 v71, v63, v76 offset:0
  s_mov_b64 exec, s[78:79]
  ds_add_rtn_u32 v72, v64, v76 offset:0
  s_mov_b64 exec, s[80:81]
  ds_add_rtn_u32 v73, v65, v76 offset:0
  s_mov_b64 exec, s[82:83]
  ds_add_rtn_u32 v74, v66, v76 offset:0
  s_mov_b64 exec, s[84:85]
  ds_add_rtn_u32 v75, v67, v76 offset:0
  s_mov_b64 exec, -1
  s_waitcnt lgkmcnt(0)
  s_barrier
  v_lshlrev_b32 v1, 2, v0
  ds_read_b32 v76, v1 offset:0
  s_waitcnt lgkmcnt(0)
  v_mov_b32 v77, v76
  s_nop 1
  v_add_u32_dpp v77, v77, v77 row_shr:1 row_mask:0xf bank_mask:0xf
  s_nop 1
  v_add_u32_dpp v77, v77, v77 row_shr:2 row_mask:0xf bank_mask:0xf
  s_nop 1
  v_add_u32_dpp v77, v77, v77 row_shr:4 row_mask:0xf bank_mask:0xf
  s_nop 1
  v_add_u32_dpp v77, v77, v77 row_shr:8 row_mask:0xf bank_mask:0xf
  s_nop 1
  v_add_u32_dpp v77, v77, v77 row_bcast:15 row_mask:0xa bank_mask:0xf
  s_nop 1
  v_add_u32_dpp v77, v77, v77 row_bcast:31 row_mask:0xc bank_mask:0xf
  s_nop 0
  v_readlane_b32 s4, v77, 63
  s_lshl_b32 s5, s66, 2
  s_add_u32 s5, s5, 4096
  v_mov_b32 v78, s4
  v_mov_b32 v79, s5
  ds_write_b32 v79, v78
  s_waitcnt lgkmcnt(0)
  s_barrier
  v_and_b32 v78, 15, v0
  v_lshlrev_b32 v78, 2, v78
  ds_read_b32 v79, v78 offset:4096
  s_waitcnt lgkmcnt(0)
  v_mov_b32 v80, v79
  s_nop 1
  v_add_u32_dpp v80, v80, v80 row_shr:1 row_mask:0xf bank_mask:0xf
  s_nop 1
  v_add_u32_dpp v80, v80, v80 row_shr:2 row_mask:0xf bank_mask:0xf
  s_nop 1
  v_add_u32_dpp v80, v80, v80 row_shr:4 row_mask:0xf bank_mask:0xf
  s_nop 1
  v_add_u32_dpp v80, v80, v80 row_shr:8 row_mask:0xf bank_mask:0xf
  v_sub_u32 v79, v80, v79
  v_readlane_b32 s67, v80, 15
  v_readlane_b32 s4, v79, s66
  v_sub_u32 v77, v77, v76
  s_nop 0
  v_add_u32 v77, s4, v77
  ds_write_b32 v1, v77 offset:0
  v_lshl_or_b32 v78, v76, 16, v77
  s_lshl_b32 s4, s2, 2
  v_lshlrev_b32 v79, 8, v0
  v_add_u32 v79, s4, v79
  s_cmp_ge_u32 s66, 6
  s_cbranch_scc1 K1_NOTAB
  buffer_store_dword v78, v79, s[48:51], 0 offen
K1_NOTAB:
  s_waitcnt lgkmcnt(0)
  s_barrier
  s_mov_b64 exec, s[70:71]
  ds_read_b32 v20, v60 offset:0
  s_mov_b64 exec, s[72:73]
  ds_read_b32 v21, v61 offset:0
  s_mov_b64 exec, s[74:75]
  ds_read_b32 v22, v62 offset:0
  s_mov_b64 exec, s[76:77]
  ds_read_b32 v23, v63 offset:0
  s_mov_b64 exec, s[78:79]
  ds_read_b32 v24, v64 offset:0
  s_mov_b64 exec, s[80:81]
  ds_read_b32 v25, v65 offset:0
  s_mov_b64 exec, s[82:83]
  ds_read_b32 v26, v66 offset:0
  s_mov_b64 exec, s[84:85]
  ds_read_b32 v27, v67 offset:0
  s_mov_b64 exec, -1
  s_waitcnt lgkmcnt(7)
  v_add_lshl_u32 v20, v20, v68, 2
  s_waitcnt lgkmcnt(6)
  v_add_lshl_u32 v21, v21, v69, 2
  s_waitcnt lgkmcnt(5)
  v_add_lshl_u32 v22, v22, v70, 2
  s_waitcnt lgkmcnt(4)
  v_add_lshl_u32 v23, v23, v71, 2
  s_waitcnt lgkmcnt(3)
  v_add_lshl_u32 v24, v24, v72, 2
  s_waitcnt lgkmcnt(2)
  v_add_lshl_u32 v25, v25, v73, 2
  s_waitcnt lgkmcnt(1)
  v_add_lshl_u32 v26, v26, v74, 2
  s_waitcnt lgkmcnt(0)
  v_add_lshl_u32 v27, v27, v75, 2
  s_mov_b64 exec, s[70:71]
  ds_write_b32 v20, v52 offset:4224
  s_mov_b64 exec, s[72:73]
  ds_write_b32 v21, v53 offset:4224
  s_mov_b64 exec, s[74:75]
  ds_write_b32 v22, v54 offset:4224
  s_mov_b64 exec, s[76:77]
  ds_write_b32 v23, v55 offset:4224
  s_mov_b64 exec, s[78:79]
  ds_write_b32 v24, v56 offset:4224
  s_mov_b64 exec, s[80:81]
  ds_write_b32 v25, v57 offset:4224
  s_mov_b64 exec, s[82:83]
  ds_write_b32 v26, v58 offset:4224
  s_mov_b64 exec, s[84:85]
  ds_write_b32 v27, v59 offset:4224
  s_mov_b64 exec, -1
  s_waitcnt lgkmcnt(0)
  s_barrier
  s_mov_b32 s68, 0
  s_mov_b32 s6, 841731191
  s_mov_b32 s7, 1078530011
  s_mov_b32 s8, 1045220557
  s_mov_b32 s9, 1084227584
  s_mov_b32 s11, 0xffff
K1_DENSE:
  s_cmp_ge_u32 s68, s67
  s_cbranch_scc1 K1_EEND
  v_add_u32 v2, s68, v0
  v_cmp_gt_u32 vcc, s67, v2
  s_and_saveexec_b64 s[14:15], vcc
  s_cbranch_execz K1_DSKIP
  v_lshlrev_b32 v3, 2, v2
  ds_read_b32 v4, v3 offset:4224
  s_waitcnt lgkmcnt(0)
  v_and_b32 v5, 0xffff, v4
  v_lshrrev_b32 v6, 16, v4
  v_lshlrev_b32 v7, 3, v5
  v_lshlrev_b32 v8, 3, v6
  ds_read_b64 v[10:11], v7 offset:30976
  ds_read_b64 v[12:13], v8 offset:30976
  v_mul_u32_u24 v7, s59, v6
  v_lshrrev_b32 v7, 20, v7
  v_mul_u32_u24 v7, 131, v7
  v_sub_u32 v6, v6, v7
  s_waitcnt lgkmcnt(0)
  v_lshlrev_b32 v14, 16, v10
  v_lshlrev_b32 v15, 16, v12
  v_and_b32 v10, s58, v10
  v_and_b32 v12, s58, v12
  v_sub_f32 v21, v14, v15
  v_sub_f32 v22, v10, v12
  v_sub_f32 v23, v11, v13
  v_cvt_pk_bf16_f32 v9, v21, v22
  v_lshlrev_b32 v21, 16, v9
  v_and_b32 v22, s58, v9
  v_cvt_pk_bf16_f32 v9, v23, v23
  v_lshlrev_b32 v23, 16, v9
  v_mul_f32 v14, v21, v21
  v_mul_f32 v15, v22, v22
  v_mul_f32 v16, v23, v23
  v_cvt_pk_bf16_f32 v9, v14, v15
  v_lshlrev_b32 v14, 16, v9
  v_and_b32 v15, s58, v9
  v_cvt_pk_bf16_f32 v9, v16, v16
  v_lshlrev_b32 v16, 16, v9
  v_add_f32 v14, v14, v15
  v_add_f32 v14, v14, v16
  v_cvt_pk_bf16_f32 v9, v14, v14
  v_lshlrev_b32 v14, 16, v9
  v_add_f32 v14, s6, v14
  v_cvt_pk_bf16_f32 v9, v14, v14
  v_lshlrev_b32 v14, 16, v9
  v_sqrt_f32 v14, v14
  s_nop 0
  v_cvt_pk_bf16_f32 v9, v14, v14
  v_lshlrev_b32 v14, 16, v9
  v_rcp_f32 v15, v14
  v_mul_f32 v16, s62, v14
  v_mul_f32 v17, s63, v14
  v_mul_f32 v18, s64, v14
  v_mul_f32 v19, s65, v14
  v_mul_f32 v10, s7, v14
  v_cvt_pk_bf16_f32 v9, v16, v17
  v_lshlrev_b32 v16, 16, v9
  v_and_b32 v17, s58, v9
  v_cvt_pk_bf16_f32 v9, v18, v19
  v_lshlrev_b32 v18, 16, v9
  v_and_b32 v19, s58, v9
  v_cvt_pk_bf16_f32 v9, v10, v10
  v_lshlrev_b32 v10, 16, v9
  v_mul_f32 v10, s8, v10
  v_cvt_pk_bf16_f32 v9, v10, v10
  v_lshlrev_b32 v10, 16, v9
  v_mul_f32 v16, 0.15915494, v16
  v_mul_f32 v17, 0.15915494, v17
  v_mul_f32 v18, 0.15915494, v18
  v_mul_f32 v19, 0.15915494, v19
  v_mul_f32 v10, 0.15915494, v10
  v_sin_f32 v16, v16
  v_sin_f32 v17, v17
  v_sin_f32 v18, v18
  v_sin_f32 v19, v19
  v_cos_f32 v10, v10
  v_mul_f32 v21, v21, v15
  v_mul_f32 v22, v22, v15
  v_mul_f32 v23, v23, v15
  v_cvt_pk_bf16_f32 v9, v21, v22
  v_lshlrev_b32 v21, 16, v9
  v_and_b32 v22, s58, v9
  v_cvt_pk_bf16_f32 v9, v23, v23
  v_lshlrev_b32 v23, 16, v9
  v_cvt_pk_bf16_f32 v9, v16, v17
  v_lshlrev_b32 v16, 16, v9
  v_and_b32 v17, s58, v9
  v_cvt_pk_bf16_f32 v9, v18, v19
  v_lshlrev_b32 v18, 16, v9
  v_and_b32 v19, s58, v9
  v_cvt_pk_bf16_f32 v9, v10, v10
  v_lshlrev_b32 v10, 16, v9
  v_add_f32 v10, 1.0, v10
  v_cvt_pk_bf16_f32 v9, v10, v10
  v_lshlrev_b32 v10, 16, v9
  v_mul_f32 v10, 0.5, v10
  v_mul_f32 v16, v16, v15
  v_mul_f32 v17, v17, v15
  v_mul_f32 v18, v18, v15
  v_mul_f32 v19, v19, v15
  v_cmp_gt_f32 vcc, s9, v14
  v_mov_b32 v9, s11
  v_cvt_pk_bf16_f32 v24, v16, v17
  v_cvt_pk_bf16_f32 v25, v18, v19
  v_cndmask_b32 v26, 0, v10, vcc
  v_cndmask_b32 v5, v9, v5, vcc
  v_mov_b32 v27, 0
  v_mul_f32 v21, v21, v26
  v_mul_f32 v22, v22, v26
  v_mul_f32 v23, v23, v26
  v_lshl_or_b32 v20, v6, 16, v5
  v_lshlrev_b32 v3, 5, v2
  buffer_store_dwordx4 v[20:23], v3, s[52:55], 0 offen
  buffer_store_dwordx4 v[24:27], v3, s[52:55], 0 offen offset:16
K1_DSKIP:
  s_mov_b64 exec, s[14:15]
  s_add_u32 s68, s68, 1024
  s_branch K1_DENSE
K1_EEND:
  s_endpgm
K1_MLP:
  s_waitcnt lgkmcnt(0)
  s_mov_b32 s36, s16
  s_mov_b32 s37, s17
  s_mov_b32 s38, 12800000
  s_mov_b32 s39, 0x20000
  s_mov_b32 s40, s26
  s_mov_b32 s41, s27
  s_mov_b32 s42, 32768
  s_mov_b32 s43, 0x20000
  s_mov_b32 s44, s28
  s_mov_b32 s45, s29
  s_mov_b32 s46, 98304
  s_mov_b32 s47, 0x20000
  s_mov_b32 s48, s32
  s_mov_b32 s49, s33
  s_mov_b32 s50, 16000000
  s_mov_b32 s51, 0x20000
  s_sub_u32 s56, s2, 60
  s_lshl_b32 s56, s56, 6
  v_lshrrev_b32 v1, 3, v0
  v_and_b32 v2, 7, v0
  v_lshlrev_b32 v3, 8, v1
  v_lshl_add_u32 v3, v2, 4, v3
  buffer_load_dwordx4 v[16:19], v3, s[40:43], 0 offen offset:0
  buffer_load_dwordx4 v[20:23], v3, s[40:43], 0 offen offset:128
  v_and_b32 v5, 63, v0
  v_lshrrev_b32 v6, 4, v5
  v_and_b32 v7, 15, v5
  s_cmp_ge_u32 s66, 8
  s_cbranch_scc1 K1_MLP_HI
  s_and_b32 s57, s66, 3
  s_lshr_b32 s59, s66, 2
  s_lshl_b32 s60, s57, 4
  s_add_u32 s61, s56, s60
  v_add_u32 v8, s61, v7
  v_lshlrev_b32 v8, 10, v8
  v_lshl_add_u32 v8, v6, 4, v8
  buffer_load_dwordx4 v[48:51], v8, s[36:39], 0 offen offset:0
  buffer_load_dwordx4 v[52:55], v8, s[36:39], 0 offen offset:64
  buffer_load_dwordx4 v[56:59], v8, s[36:39], 0 offen offset:128
  buffer_load_dwordx4 v[60:63], v8, s[36:39], 0 offen offset:192
  v_lshrrev_b32 v10, 1, v2
  v_and_b32 v11, 3, v1
  v_xor_b32 v10, v10, v11
  v_lshlrev_b32 v10, 5, v10
  v_and_b32 v11, 1, v2
  v_lshl_add_u32 v10, v11, 4, v10
  v_bfe_u32 v11, v1, 3, 1
  v_lshl_add_u32 v10, v11, 7, v10
  v_lshl_add_u32 v11, v1, 8, v10
  v_xor_b32 v12, 128, v11
  s_waitcnt vmcnt(4)
  ds_write_b128 v11, v[16:19]
  ds_write_b128 v12, v[20:23]
  v_bfe_u32 v1, v5, 2, 2
  v_and_b32 v2, 3, v5
  v_and_b32 v3, 1, v6
  v_lshl_add_u32 v3, v3, 2, v1
  v_lshl_add_u32 v4, v6, 3, v1
  s_waitcnt lgkmcnt(0)
  s_barrier
  s_lshl_b32 s4, s59, 2
  s_add_u32 s5, s4, 0
  v_xor_b32 v10, s5, v3
  v_lshlrev_b32 v10, 5, v10
  v_lshl_add_u32 v10, v2, 3, v10
  v_lshl_add_u32 v10, v4, 8, v10
  ds_read_b64_tr_b16 v[64:65], v10 offset:0
  ds_read_b64_tr_b16 v[66:67], v10 offset:1024
  ds_read_b64_tr_b16 v[68:69], v10 offset:8192
  ds_read_b64_tr_b16 v[70:71], v10 offset:9216
  ds_read_b64_tr_b16 v[72:73], v10 offset:16384
  ds_read_b64_tr_b16 v[74:75], v10 offset:17408
  ds_read_b64_tr_b16 v[76:77], v10 offset:24576
  ds_read_b64_tr_b16 v[78:79], v10 offset:25600
  s_add_u32 s5, s4, 1
  v_xor_b32 v10, s5, v3
  v_lshlrev_b32 v10, 5, v10
  v_lshl_add_u32 v10, v2, 3, v10
  v_lshl_add_u32 v10, v4, 8, v10
  ds_read_b64_tr_b16 v[80:81], v10 offset:0
  ds_read_b64_tr_b16 v[82:83], v10 offset:1024
  ds_read_b64_tr_b16 v[84:85], v10 offset:8192
  ds_read_b64_tr_b16 v[86:87], v10 offset:9216
  ds_read_b64_tr_b16 v[88:89], v10 offset:16384
  ds_read_b64_tr_b16 v[90:91], v10 offset:17408
  ds_read_b64_tr_b16 v[92:93], v10 offset:24576
  ds_read_b64_tr_b16 v[94:95], v10 offset:25600
  s_add_u32 s5, s4, 2
  v_xor_b32 v10, s5, v3
  v_lshlrev_b32 v10, 5, v10
  v_lshl_add_u32 v10, v2, 3, v10
  v_lshl_add_u32 v10, v4, 8, v10
  ds_read_b64_tr_b16 v[96:97], v10 offset:0
  ds_read_b64_tr_b16 v[98:99], v10 offset:1024
  ds_read_b64_tr_b16 v[100:101], v10 offset:8192
  ds_read_b64_tr_b16 v[102:103], v10 offset:9216
  ds_read_b64_tr_b16 v[104:105], v10 offset:16384
  ds_read_b64_tr_b16 v[106:107], v10 offset:17408
  ds_read_b64_tr_b16 v[108:109], v10 offset:24576
  ds_read_b64_tr_b16 v[110:111], v10 offset:25600
  s_add_u32 s5, s4, 3
  v_xor_b32 v10, s5, v3
  v_lshlrev_b32 v10, 5, v10
  v_lshl_add_u32 v10, v2, 3, v10
  v_lshl_add_u32 v10, v4, 8, v10
  ds_read_b64_tr_b16 v[112:113], v10 offset:0
  ds_read_b64_tr_b16 v[114:115], v10 offset:1024
  ds_read_b64_tr_b16 v[116:117], v10 offset:8192
  ds_read_b64_tr_b16 v[118:119], v10 offset:9216
  ds_read_b64_tr_b16 v[120:121], v10 offset:16384
  ds_read_b64_tr_b16 v[122:123], v10 offset:17408
  ds_read_b64_tr_b16 v[124:125], v10 offset:24576
  ds_read_b64_tr_b16 v[126:127], v10 offset:25600
  v_add_u32 v11, s60, v7
  v_mul_u32_u24 v11, 272, v11
  v_add_u32 v11, 131072, v11
  s_lshl_b32 s4, s59, 7
  v_lshl_add_u32 v12, v6, 3, v11
  v_add_u32 v12, s4, v12
  s_waitcnt vmcnt(0)
  s_waitcnt lgkmcnt(15)
  v_mfma_f32_16x16x32_bf16 v[24:27], v[64:67], v[48:51], 0
  s_waitcnt lgkmcnt(15)
  v_mfma_f32_16x16x32_bf16 v[24:27], v[68:71], v[52:55], v[24:27]
  s_waitcnt lgkmcnt(15)
  v_mfma_f32_16x16x32_bf16 v[24:27], v[72:75], v[56:59], v[24:27]
  s_waitcnt lgkmcnt(15)
  v_mfma_f32_16x16x32_bf16 v[24:27], v[76:79], v[60:63], v[24:27]
  s_waitcnt lgkmcnt(15)
  v_mfma_f32_16x16x32_bf16 v[28:31], v[80:83], v[48:51], 0
  s_waitcnt lgkmcnt(15)
  v_mfma_f32_16x16x32_bf16 v[28:31], v[84:87], v[52:55], v[28:31]
  s_waitcnt lgkmcnt(15)
  v_mfma_f32_16x16x32_bf16 v[28:31], v[88:91], v[56:59], v[28:31]
  s_waitcnt lgkmcnt(15)
  v_mfma_f32_16x16x32_bf16 v[28:31], v[92:95], v[60:63], v[28:31]
  s_waitcnt lgkmcnt(14)
  v_mfma_f32_16x16x32_bf16 v[32:35], v[96:99], v[48:51], 0
  s_waitcnt lgkmcnt(12)
  v_mfma_f32_16x16x32_bf16 v[32:35], v[100:103], v[52:55], v[32:35]
  s_waitcnt lgkmcnt(10)
  v_mfma_f32_16x16x32_bf16 v[32:35], v[104:107], v[56:59], v[32:35]
  s_waitcnt lgkmcnt(8)
  v_mfma_f32_16x16x32_bf16 v[32:35], v[108:111], v[60:63], v[32:35]
  s_waitcnt lgkmcnt(6)
  v_mfma_f32_16x16x32_bf16 v[36:39], v[112:115], v[48:51], 0
  s_waitcnt lgkmcnt(4)
  v_mfma_f32_16x16x32_bf16 v[36:39], v[116:119], v[52:55], v[36:39]
  s_waitcnt lgkmcnt(2)
  v_mfma_f32_16x16x32_bf16 v[36:39], v[120:123], v[56:59], v[36:39]
  s_waitcnt lgkmcnt(0)
  v_mfma_f32_16x16x32_bf16 v[36:39], v[124:127], v[60:63], v[36:39]
  s_mov_b32 s5, 3216550459
  v_cvt_pk_bf16_f32 v15, v24, v25
  v_lshlrev_b32 v24, 16, v15
  v_and_b32 v25, s58, v15
  v_cvt_pk_bf16_f32 v15, v26, v27
  v_lshlrev_b32 v26, 16, v15
  v_and_b32 v27, s58, v15
  v_mul_f32 v40, s5, v24
  v_mul_f32 v41, s5, v25
  v_mul_f32 v42, s5, v26
  v_mul_f32 v43, s5, v27
  v_exp_f32 v40, v40
  v_exp_f32 v41, v41
  v_exp_f32 v42, v42
  v_exp_f32 v43, v43
  v_add_f32 v40, 1.0, v40
  v_add_f32 v41, 1.0, v41
  v_add_f32 v42, 1.0, v42
  v_add_f32 v43, 1.0, v43
  v_rcp_f32 v40, v40
  v_rcp_f32 v41, v41
  v_rcp_f32 v42, v42
  v_rcp_f32 v43, v43
  v_mul_f32 v24, v24, v40
  v_mul_f32 v25, v25, v41
  v_mul_f32 v26, v26, v42
  v_mul_f32 v27, v27, v43
  v_cvt_pk_bf16_f32 v44, v24, v25
  v_cvt_pk_bf16_f32 v45, v26, v27
  ds_write_b64 v12, v[44:45] offset:0
  v_cvt_pk_bf16_f32 v15, v28, v29
  v_lshlrev_b32 v28, 16, v15
  v_and_b32 v29, s58, v15
  v_cvt_pk_bf16_f32 v15, v30, v31
  v_lshlrev_b32 v30, 16, v15
  v_and_b32 v31, s58, v15
  v_mul_f32 v40, s5, v28
  v_mul_f32 v41, s5, v29
  v_mul_f32 v42, s5, v30
  v_mul_f32 v43, s5, v31
  v_exp_f32 v40, v40
  v_exp_f32 v41, v41
  v_exp_f32 v42, v42
  v_exp_f32 v43, v43
  v_add_f32 v40, 1.0, v40
  v_add_f32 v41, 1.0, v41
  v_add_f32 v42, 1.0, v42
  v_add_f32 v43, 1.0, v43
  v_rcp_f32 v40, v40
  v_rcp_f32 v41, v41
  v_rcp_f32 v42, v42
  v_rcp_f32 v43, v43
  v_mul_f32 v28, v28, v40
  v_mul_f32 v29, v29, v41
  v_mul_f32 v30, v30, v42
  v_mul_f32 v31, v31, v43
  v_cvt_pk_bf16_f32 v46, v28, v29
  v_cvt_pk_bf16_f32 v47, v30, v31
  ds_write_b64 v12, v[46:47] offset:32
  v_cvt_pk_bf16_f32 v15, v32, v33
  v_lshlrev_b32 v32, 16, v15
  v_and_b32 v33, s58, v15
  v_cvt_pk_bf16_f32 v15, v34, v35
  v_lshlrev_b32 v34, 16, v15
  v_and_b32 v35, s58, v15
  v_mul_f32 v40, s5, v32
  v_mul_f32 v41, s5, v33
  v_mul_f32 v42, s5, v34
  v_mul_f32 v43, s5, v35
  v_exp_f32 v40, v40
  v_exp_f32 v41, v41
  v_exp_f32 v42, v42
  v_exp_f32 v43, v43
  v_add_f32 v40, 1.0, v40
  v_add_f32 v41, 1.0, v41
  v_add_f32 v42, 1.0, v42
  v_add_f32 v43, 1.0, v43
  v_rcp_f32 v40, v40
  v_rcp_f32 v41, v41
  v_rcp_f32 v42, v42
  v_rcp_f32 v43, v43
  v_mul_f32 v32, v32, v40
  v_mul_f32 v33, v33, v41
  v_mul_f32 v34, v34, v42
  v_mul_f32 v35, v35, v43
  v_cvt_pk_bf16_f32 v44, v32, v33
  v_cvt_pk_bf16_f32 v45, v34, v35
  ds_write_b64 v12, v[44:45] offset:64
  v_cvt_pk_bf16_f32 v15, v36, v37
  v_lshlrev_b32 v36, 16, v15
  v_and_b32 v37, s58, v15
  v_cvt_pk_bf16_f32 v15, v38, v39
  v_lshlrev_b32 v38, 16, v15
  v_and_b32 v39, s58, v15
  v_mul_f32 v40, s5, v36
  v_mul_f32 v41, s5, v37
  v_mul_f32 v42, s5, v38
  v_mul_f32 v43, s5, v39
  v_exp_f32 v40, v40
  v_exp_f32 v41, v41
  v_exp_f32 v42, v42
  v_exp_f32 v43, v43
  v_add_f32 v40, 1.0, v40
  v_add_f32 v41, 1.0, v41
  v_add_f32 v42, 1.0, v42
  v_add_f32 v43, 1.0, v43
  v_rcp_f32 v40, v40
  v_rcp_f32 v41, v41
  v_rcp_f32 v42, v42
  v_rcp_f32 v43, v43
  v_mul_f32 v36, v36, v40
  v_mul_f32 v37, v37, v41
  v_mul_f32 v38, v38, v42
  v_mul_f32 v39, v39, v43
  v_cvt_pk_bf16_f32 v46, v36, v37
  v_cvt_pk_bf16_f32 v47, v38, v39
  ds_write_b64 v12, v[46:47] offset:96
  s_branch K1_MLP_J
K1_MLP_HI:
  v_subrev_u32 v8, 512, v0
  v_lshrrev_b32 v9, 3, v8
  v_mul_u32_u24 v4, 768, v9
  v_lshl_add_u32 v4, v2, 4, v4
  v_add_u32 v13, 49152, v4
  buffer_load_dwordx4 v[64:67], v4, s[44:47], 0 offen offset:0
  buffer_load_dwordx4 v[68:71], v4, s[44:47], 0 offen offset:128
  v_lshrrev_b32 v10, 1, v2
  v_and_b32 v11, 3, v1
  v_xor_b32 v10, v10, v11
  v_lshlrev_b32 v10, 5, v10
  v_and_b32 v11, 1, v2
  v_lshl_add_u32 v10, v11, 4, v10
  v_bfe_u32 v11, v1, 3, 1
  v_lshl_add_u32 v10, v11, 7, v10
  v_lshl_add_u32 v11, v1, 8, v10
  v_xor_b32 v12, 128, v11
  s_waitcnt vmcnt(2)
  ds_write_b128 v11, v[16:19]
  ds_write_b128 v12, v[20:23]
  s_waitcnt lgkmcnt(0)
  s_barrier
  buffer_load_dwordx4 v[72:75], v4, s[44:47], 0 offen offset:256
  buffer_load_dwordx4 v[76:79], v4, s[44:47], 0 offen offset:384
  buffer_load_dwordx4 v[80:83], v4, s[44:47], 0 offen offset:512
  buffer_load_dwordx4 v[84:87], v4, s[44:47], 0 offen offset:640
  buffer_load_dwordx4 v[88:91], v13, s[44:47], 0 offen offset:0
  buffer_load_dwordx4 v[92:95], v13, s[44:47], 0 offen offset:128
  buffer_load_dwordx4 v[96:99], v13, s[44:47], 0 offen offset:256
  buffer_load_dwordx4 v[100:103], v13, s[44:47], 0 offen offset:384
  buffer_load_dwordx4 v[104:107], v13, s[44:47], 0 offen offset:512
  buffer_load_dwordx4 v[108:111], v13, s[44:47], 0 offen offset:640
  v_lshrrev_b32 v10, 1, v2
  v_and_b32 v11, 3, v9
  v_xor_b32 v10, v10, v11
  v_lshlrev_b32 v10, 5, v10
  v_and_b32 v11, 1, v2
  v_lshl_add_u32 v10, v11, 4, v10
  v_bfe_u32 v11, v9, 3, 1
  v_lshl_add_u32 v10, v11, 7, v10
  v_mul_u32_u24 v13, 768, v9
  v_add_u32 v13, v13, v10
  v_add_u32 v13, 32768, v13
  v_xor_b32 v14, 128, v13
  v_bfe_u32 v1, v5, 2, 2
  v_and_b32 v2, 3, v5
  v_and_b32 v3, 1, v6
  v_lshl_add_u32 v3, v3, 2, v1
  v_lshl_add_u32 v4, v6, 3, v1
  s_waitcnt vmcnt(11)
  ds_write_b128 v13, v[64:67] offset:0
  s_waitcnt vmcnt(10)
  ds_write_b128 v14, v[68:71] offset:0
  s_waitcnt vmcnt(9)
  ds_write_b128 v13, v[72:75] offset:256
  s_waitcnt vmcnt(8)
  ds_write_b128 v14, v[76:79] offset:256
  s_waitcnt vmcnt(7)
  ds_write_b128 v13, v[80:83] offset:512
  s_waitcnt vmcnt(6)
  ds_write_b128 v14, v[84:87] offset:512
  s_waitcnt vmcnt(5)
  ds_write_b128 v13, v[88:91] offset:49152
  s_waitcnt vmcnt(4)
  ds_write_b128 v14, v[92:95] offset:49152
  s_waitcnt vmcnt(3)
  ds_write_b128 v13, v[96:99] offset:49408
  s_waitcnt vmcnt(2)
  ds_write_b128 v14, v[100:103] offset:49408
  s_waitcnt vmcnt(1)
  ds_write_b128 v13, v[104:107] offset:49664
  s_waitcnt vmcnt(0)
  ds_write_b128 v14, v[108:111] offset:49664
K1_MLP_J:
  s_and_b32 s57, s66, 1
  s_lshr_b32 s59, s66, 1
  s_lshl_b32 s60, s57, 5
  s_add_u32 s61, s56, s60
  v_add_u32 v11, s60, v7
  v_mul_u32_u24 v11, 272, v11
  v_add_u32 v11, 131072, v11
  s_mul_i32 s4, s59, 96
  v_mul_u32_u24 v13, 24, v2
  v_add_u32 v13, s4, v13
  v_mul_u32_u24 v14, 768, v4
  v_add_u32 v14, 32768, v14
  v_add_u32 v15, 0, v13
  v_lshrrev_b32 v22, 5, v15
  v_xor_b32 v22, v22, v3
  v_and_b32 v15, 31, v15
  v_lshl_add_u32 v15, v22, 5, v15
  v_add_u32 v16, v14, v15
  v_add_u32 v17, 49152, v16
  v_add_u32 v15, 8, v13
  v_lshrrev_b32 v22, 5, v15
  v_xor_b32 v22, v22, v3
  v_and_b32 v15, 31, v15
  v_lshl_add_u32 v15, v22, 5, v15
  v_add_u32 v18, v14, v15
  v_add_u32 v19, 49152, v18
  v_add_u32 v15, 16, v13
  v_lshrrev_b32 v22, 5, v15
  v_xor_b32 v22, v22, v3
  v_and_b32 v15, 31, v15
  v_lshl_add_u32 v15, v22, 5, v15
  v_add_u32 v20, v14, v15
  v_add_u32 v21, 49152, v20
  v_lshl_add_u32 v12, v6, 4, v11
  s_waitcnt lgkmcnt(0)
  s_barrier
  ds_read_b128 v[48:51], v12 offset:0
  ds_read_b128 v[52:55], v12 offset:64
  ds_read_b128 v[56:59], v12 offset:128
  ds_read_b128 v[60:63], v12 offset:192
  ds_read_b128 v[64:67], v12 offset:4352
  ds_read_b128 v[68:71], v12 offset:4416
  ds_read_b128 v[72:75], v12 offset:4480
  ds_read_b128 v[76:79], v12 offset:4544
  ds_read_b64_tr_b16 v[80:81], v16 offset:0
  ds_read_b64_tr_b16 v[82:83], v16 offset:3072
  ds_read_b64_tr_b16 v[84:85], v16 offset:24576
  ds_read_b64_tr_b16 v[86:87], v16 offset:27648
  ds_read_b64_tr_b16 v[88:89], v17 offset:0
  ds_read_b64_tr_b16 v[90:91], v17 offset:3072
  ds_read_b64_tr_b16 v[92:93], v17 offset:24576
  ds_read_b64_tr_b16 v[94:95], v17 offset:27648
  ds_read_b64_tr_b16 v[96:97], v18 offset:0
  ds_read_b64_tr_b16 v[98:99], v18 offset:3072
  ds_read_b64_tr_b16 v[100:101], v18 offset:24576
  ds_read_b64_tr_b16 v[102:103], v18 offset:27648
  ds_read_b64_tr_b16 v[104:105], v19 offset:0
  ds_read_b64_tr_b16 v[106:107], v19 offset:3072
  ds_read_b64_tr_b16 v[108:109], v19 offset:24576
  ds_read_b64_tr_b16 v[110:111], v19 offset:27648
  ds_read_b64_tr_b16 v[112:113], v20 offset:0
  ds_read_b64_tr_b16 v[114:115], v20 offset:3072
  ds_read_b64_tr_b16 v[116:117], v20 offset:24576
  ds_read_b64_tr_b16 v[118:119], v20 offset:27648
  ds_read_b64_tr_b16 v[120:121], v21 offset:0
  ds_read_b64_tr_b16 v[122:123], v21 offset:3072
  ds_read_b64_tr_b16 v[124:125], v21 offset:24576
  ds_read_b64_tr_b16 v[126:127], v21 offset:27648
  s_mov_b32 s5, 21846
  v_add_u32 v13, 0, v0
  v_mul_u32_u24 v1, s5, v13
  v_lshrrev_b32 v1, 20, v1
  v_mul_u32_u24 v14, 48, v1
  v_sub_u32 v14, v13, v14
  v_lshl_or_b32 v1, v1, 8, v14
  v_add_u32 v13, 1024, v0
  v_mul_u32_u24 v2, s5, v13
  v_lshrrev_b32 v2, 20, v2
  v_mul_u32_u24 v14, 48, v2
  v_sub_u32 v14, v13, v14
  v_lshl_or_b32 v2, v2, 8, v14
  v_add_u32 v13, 2048, v0
  v_mul_u32_u24 v3, s5, v13
  v_lshrrev_b32 v3, 20, v3
  v_mul_u32_u24 v14, 48, v3
  v_sub_u32 v14, v13, v14
  v_lshl_or_b32 v3, v3, 8, v14
  s_waitcnt lgkmcnt(15)
  v_mfma_f32_16x16x32_bf16 v[24:27], v[80:83], v[48:51], 0
  v_mfma_f32_16x16x32_bf16 v[28:31], v[80:83], v[64:67], 0
  s_waitcnt lgkmcnt(15)
  v_mfma_f32_16x16x32_bf16 v[24:27], v[84:87], v[52:55], v[24:27]
  v_mfma_f32_16x16x32_bf16 v[28:31], v[84:87], v[68:71], v[28:31]
  s_waitcnt lgkmcnt(15)
  v_mfma_f32_16x16x32_bf16 v[24:27], v[88:91], v[56:59], v[24:27]
  v_mfma_f32_16x16x32_bf16 v[28:31], v[88:91], v[72:75], v[28:31]
  s_waitcnt lgkmcnt(15)
  v_mfma_f32_16x16x32_bf16 v[24:27], v[92:95], v[60:63], v[24:27]
  v_mfma_f32_16x16x32_bf16 v[28:31], v[92:95], v[76:79], v[28:31]
  s_waitcnt lgkmcnt(14)
  v_mfma_f32_16x16x32_bf16 v[32:35], v[96:99], v[48:51], 0
  v_mfma_f32_16x16x32_bf16 v[36:39], v[96:99], v[64:67], 0
  s_waitcnt lgkmcnt(12)
  v_mfma_f32_16x16x32_bf16 v[32:35], v[100:103], v[52:55], v[32:35]
  v_mfma_f32_16x16x32_bf16 v[36:39], v[100:103], v[68:71], v[36:39]
  s_waitcnt lgkmcnt(10)
  v_mfma_f32_16x16x32_bf16 v[32:35], v[104:107], v[56:59], v[32:35]
  v_mfma_f32_16x16x32_bf16 v[36:39], v[104:107], v[72:75], v[36:39]
  s_waitcnt lgkmcnt(8)
  v_mfma_f32_16x16x32_bf16 v[32:35], v[108:111], v[60:63], v[32:35]
  v_mfma_f32_16x16x32_bf16 v[36:39], v[108:111], v[76:79], v[36:39]
  v_lshrrev_b32 v13, 8, v1
  v_add_u32 v13, s56, v13
  v_and_b32 v14, 255, v1
  v_lshlrev_b32 v14, 4, v14
  v_lshl_add_u32 v13, v13, 10, v14
  buffer_load_dwordx4 v[80:83], v13, s[36:39], 0 offen offset:256
  v_lshrrev_b32 v13, 8, v2
  v_add_u32 v13, s56, v13
  v_and_b32 v14, 255, v2
  v_lshlrev_b32 v14, 4, v14
  v_lshl_add_u32 v13, v13, 10, v14
  buffer_load_dwordx4 v[84:87], v13, s[36:39], 0 offen offset:256
  v_lshrrev_b32 v13, 8, v3
  v_add_u32 v13, s56, v13
  v_and_b32 v14, 255, v3
  v_lshlrev_b32 v14, 4, v14
  v_lshl_add_u32 v13, v13, 10, v14
  buffer_load_dwordx4 v[88:91], v13, s[36:39], 0 offen offset:256
  s_waitcnt lgkmcnt(6)
  v_mfma_f32_16x16x32_bf16 v[40:43], v[112:115], v[48:51], 0
  v_mfma_f32_16x16x32_bf16 v[44:47], v[112:115], v[64:67], 0
  s_waitcnt lgkmcnt(4)
  v_mfma_f32_16x16x32_bf16 v[40:43], v[116:119], v[52:55], v[40:43]
  v_mfma_f32_16x16x32_bf16 v[44:47], v[116:119], v[68:71], v[44:47]
  s_waitcnt lgkmcnt(2)
  v_mfma_f32_16x16x32_bf16 v[40:43], v[120:123], v[56:59], v[40:43]
  v_mfma_f32_16x16x32_bf16 v[44:47], v[120:123], v[72:75], v[44:47]
  s_waitcnt lgkmcnt(0)
  s_barrier
  v_mfma_f32_16x16x32_bf16 v[40:43], v[124:127], v[60:63], v[40:43]
  v_mfma_f32_16x16x32_bf16 v[44:47], v[124:127], v[76:79], v[44:47]
  v_add_u32 v8, s60, v7
  v_mul_u32_u24 v8, 784, v8
  v_mul_u32_u24 v9, 24, v6
  v_add3_u32 v8, v8, v9, s4
  v_cvt_pk_bf16_f32 v96, v24, v25
  v_cvt_pk_bf16_f32 v97, v26, v27
  ds_write_b64 v8, v[96:97] offset:0
  v_cvt_pk_bf16_f32 v98, v32, v33
  v_cvt_pk_bf16_f32 v99, v34, v35
  ds_write_b64 v8, v[98:99] offset:8
  v_cvt_pk_bf16_f32 v100, v40, v41
  v_cvt_pk_bf16_f32 v101, v42, v43
  ds_write_b64 v8, v[100:101] offset:16
  v_cvt_pk_bf16_f32 v104, v28, v29
  v_cvt_pk_bf16_f32 v105, v30, v31
  ds_write_b64 v8, v[104:105] offset:12544
  v_cvt_pk_bf16_f32 v106, v36, v37
  v_cvt_pk_bf16_f32 v107, v38, v39
  ds_write_b64 v8, v[106:107] offset:12552
  v_cvt_pk_bf16_f32 v108, v44, v45
  v_cvt_pk_bf16_f32 v109, v46, v47
  ds_write_b64 v8, v[108:109] offset:12560
  s_mul_i32 s6, s56, 1280
  v_add_u32 v13, 0, v0
  v_lshrrev_b32 v14, 5, v13
  v_and_b32 v13, 31, v13
  v_mul_u32_u24 v16, 784, v14
  v_lshl_add_u32 v16, v13, 4, v16
  v_and_b32 v15, 16, v13
  v_lshl_add_u32 v16, v15, 4, v16
  v_mul_u32_u24 v10, 1280, v14
  v_lshl_add_u32 v10, v13, 4, v10
  v_add_u32 v10, s6, v10
  v_add_u32 v13, 1024, v0
  v_lshrrev_b32 v14, 5, v13
  v_and_b32 v13, 31, v13
  v_mul_u32_u24 v17, 784, v14
  v_lshl_add_u32 v17, v13, 4, v17
  v_and_b32 v15, 16, v13
  v_lshl_add_u32 v17, v15, 4, v17
  v_mul_u32_u24 v11, 1280, v14
  v_lshl_add_u32 v11, v13, 4, v11
  v_add_u32 v11, s6, v11
  v_lshrrev_b32 v14, 8, v1
  v_and_b32 v13, 255, v1
  v_mul_u32_u24 v18, 784, v14
  v_and_b32 v15, 15, v13
  v_lshl_add_u32 v18, v15, 4, v18
  v_mul_u32_u24 v1, 1280, v14
  v_lshl_add_u32 v1, v13, 4, v1
  v_add_u32 v1, s6, v1
  v_lshrrev_b32 v14, 8, v2
  v_and_b32 v13, 255, v2
  v_mul_u32_u24 v19, 784, v14
  v_and_b32 v15, 15, v13
  v_lshl_add_u32 v19, v15, 4, v19
  v_mul_u32_u24 v2, 1280, v14
  v_lshl_add_u32 v2, v13, 4, v2
  v_add_u32 v2, s6, v2
  v_lshrrev_b32 v14, 8, v3
  v_and_b32 v13, 255, v3
  v_mul_u32_u24 v20, 784, v14
  v_and_b32 v15, 15, v13
  v_lshl_add_u32 v20, v15, 4, v20
  v_mul_u32_u24 v3, 1280, v14
  v_lshl_add_u32 v3, v13, 4, v3
  v_add_u32 v3, s6, v3
  v_mov_b32 v22, 0xffff0000
  s_waitcnt lgkmcnt(0)
  s_barrier
  ds_read_b128 v[24:27], v16
  ds_read_b128 v[28:31], v17
  ds_read_b128 v[32:35], v18 offset:256
  ds_read_b128 v[36:39], v19 offset:256
  ds_read_b128 v[40:43], v20 offset:256
  s_waitcnt lgkmcnt(4)
  buffer_store_dwordx4 v[24:27], v10, s[48:51], 0 offen sc1
  s_waitcnt lgkmcnt(3)
  buffer_store_dwordx4 v[28:31], v11, s[48:51], 0 offen sc1
  s_waitcnt lgkmcnt(2) vmcnt(4)
  v_lshlrev_b32 v44, 16, v32
  v_lshlrev_b32 v45, 16, v80
  v_and_b32 v32, v22, v32
  v_and_b32 v80, v22, v80
  v_mul_f32 v44, v44, v45
  v_mul_f32 v32, v32, v80
  v_cvt_pk_bf16_f32 v32, v44, v32
  v_lshlrev_b32 v44, 16, v33
  v_lshlrev_b32 v45, 16, v81
  v_and_b32 v33, v22, v33
  v_and_b32 v81, v22, v81
  v_mul_f32 v44, v44, v45
  v_mul_f32 v33, v33, v81
  v_cvt_pk_bf16_f32 v33, v44, v33
  v_lshlrev_b32 v44, 16, v34
  v_lshlrev_b32 v45, 16, v82
  v_and_b32 v34, v22, v34
  v_and_b32 v82, v22, v82
  v_mul_f32 v44, v44, v45
  v_mul_f32 v34, v34, v82
  v_cvt_pk_bf16_f32 v34, v44, v34
  v_lshlrev_b32 v44, 16, v35
  v_lshlrev_b32 v45, 16, v83
  v_and_b32 v35, v22, v35
  v_and_b32 v83, v22, v83
  v_mul_f32 v44, v44, v45
  v_mul_f32 v35, v35, v83
  v_cvt_pk_bf16_f32 v35, v44, v35
  buffer_store_dwordx4 v[32:35], v1, s[48:51], 0 offen offset:512 sc1
  s_waitcnt lgkmcnt(1) vmcnt(4)
  v_lshlrev_b32 v44, 16, v36
  v_lshlrev_b32 v45, 16, v84
  v_and_b32 v36, v22, v36
  v_and_b32 v84, v22, v84
  v_mul_f32 v44, v44, v45
  v_mul_f32 v36, v36, v84
  v_cvt_pk_bf16_f32 v36, v44, v36
  v_lshlrev_b32 v44, 16, v37
  v_lshlrev_b32 v45, 16, v85
  v_and_b32 v37, v22, v37
  v_and_b32 v85, v22, v85
  v_mul_f32 v44, v44, v45
  v_mul_f32 v37, v37, v85
  v_cvt_pk_bf16_f32 v37, v44, v37
  v_lshlrev_b32 v44, 16, v38
  v_lshlrev_b32 v45, 16, v86
  v_and_b32 v38, v22, v38
  v_and_b32 v86, v22, v86
  v_mul_f32 v44, v44, v45
  v_mul_f32 v38, v38, v86
  v_cvt_pk_bf16_f32 v38, v44, v38
  v_lshlrev_b32 v44, 16, v39
  v_lshlrev_b32 v45, 16, v87
  v_and_b32 v39, v22, v39
  v_and_b32 v87, v22, v87
  v_mul_f32 v44, v44, v45
  v_mul_f32 v39, v39, v87
  v_cvt_pk_bf16_f32 v39, v44, v39
  buffer_store_dwordx4 v[36:39], v2, s[48:51], 0 offen offset:512 sc1
  s_waitcnt lgkmcnt(0) vmcnt(4)
  v_lshlrev_b32 v44, 16, v40
  v_lshlrev_b32 v45, 16, v88
  v_and_b32 v40, v22, v40
  v_and_b32 v88, v22, v88
  v_mul_f32 v44, v44, v45
  v_mul_f32 v40, v40, v88
  v_cvt_pk_bf16_f32 v40, v44, v40
  v_lshlrev_b32 v44, 16, v41
  v_lshlrev_b32 v45, 16, v89
  v_and_b32 v41, v22, v41
  v_and_b32 v89, v22, v89
  v_mul_f32 v44, v44, v45
  v_mul_f32 v41, v41, v89
  v_cvt_pk_bf16_f32 v41, v44, v41
  v_lshlrev_b32 v44, 16, v42
  v_lshlrev_b32 v45, 16, v90
  v_and_b32 v42, v22, v42
  v_and_b32 v90, v22, v90
  v_mul_f32 v44, v44, v45
  v_mul_f32 v42, v42, v90
  v_cvt_pk_bf16_f32 v42, v44, v42
  v_lshlrev_b32 v44, 16, v43
  v_lshlrev_b32 v45, 16, v91
  v_and_b32 v43, v22, v43
  v_and_b32 v91, v22, v91
  v_mul_f32 v44, v44, v45
  v_mul_f32 v43, v43, v91
  v_cvt_pk_bf16_f32 v43, v44, v43
  buffer_store_dwordx4 v[40:43], v3, s[48:51], 0 offen offset:512 sc1
K1_END:
  s_endpgm
.globl painn_k2_kernel
.p2align 8
.type painn_k2_kernel,@function
painn_k2_kernel:
  s_cmp_ge_u32 s2, 768
  s_cbranch_scc1 K2_END
  s_load_dwordx2 s[16:17], s[0:1], 0
  s_load_dwordx2 s[30:31], s[0:1], 64
  s_load_dwordx2 s[34:35], s[0:1], 80
  v_lshrrev_b32 v8, 6, v0
  s_nop 0
  v_readfirstlane_b32 s65, v8
  s_lshr_b32 s4, s2, 3
  s_mul_i32 s66, s4, 131
  s_and_b32 s5, s2, 3
  s_lshl_b32 s13, s4, 2
  s_or_b32 s13, s13, s5
  s_bfe_u32 s14, s2, 0x10002
  s_mov_b32 s68, 0
  s_mov_b32 s64, 0
  s_mov_b32 s12, 0
  v_mov_b32 v12, 0xffff0000
  v_mov_b32 v15, 0xfffff000
  v_and_b32 v8, 63, v0
  v_and_b32 v9, 7, v0
  v_lshlrev_b32 v1, 4, v9
  s_lshl_b32 s4, s14, 7
  v_add_u32 v1, s4, v1
  v_bfe_u32 v10, v0, 3, 3
  v_lshlrev_b32 v2, 5, v10
  v_bfe_u32 v10, v0, 4, 2
  v_and_b32 v11, 3, v0
  v_cmp_eq_u32 vcc, v11, v10
  v_bfe_u32 v11, v0, 2, 2
  v_lshlrev_b32 v11, 6, v11
  v_mov_b32 v7, 42880
  v_cndmask_b32 v4, v7, v11, vcc
  v_cndmask_b32 v3, 0, 1, vcc
  v_and_b32 v11, 8, v0
  v_cmp_ne_u32 s[28:29], 0, v11
  s_lshl_b32 s4, s13, 5
  s_add_u32 s4, s4, 16990208
  s_add_u32 s5, s4, 16
  s_waitcnt lgkmcnt(0)
  s_load_dwordx4 s[8:11], s[34:35], s4
  s_load_dwordx2 s[100:101], s[34:35], s5
  s_add_u32 s48, s34, 17039360
  s_addc_u32 s49, s35, 0
  s_mov_b32 s50, 262144
  s_mov_b32 s51, 0x20000
  s_lshl_b32 s4, s13, 8
  v_lshlrev_b32 v11, 2, v8
  buffer_load_dword v6, v11, s[48:51], s4 offen
  s_add_u32 s56, s34, 16973824
  s_addc_u32 s57, s35, 0
  s_mov_b32 s58, 12288
  s_mov_b32 s59, 0x20000
  s_min_u32 s4, s65, 2
  s_mul_i32 s4, s4, 2048
  v_lshlrev_b32 v11, 4, v8
  v_add_u32 v39, s4, v11
  s_mul_i32 s5, s14, 6144
  buffer_load_dwordx4 v[16:19], v39, s[56:59], s5 offen offset:0
  buffer_load_dwordx4 v[20:23], v39, s[56:59], s5 offen offset:1024
  s_mov_b32 s36, s16
  s_mov_b32 s37, s17
  s_mov_b32 s38, 12800000
  s_mov_b32 s39, 0x20000
  s_mov_b32 s40, s34
  s_mov_b32 s41, s35
  s_mov_b32 s42, 16000000
  s_mov_b32 s43, 0x20000
  s_add_u32 s52, s34, 17301504
  s_addc_u32 s53, s35, 0
  s_mov_b32 s54, 12802560
  s_mov_b32 s55, 0x20000
  s_mov_b32 s44, s30
  s_mov_b32 s45, s31
  s_mov_b32 s46, 12800000
  s_mov_b32 s47, 0x20000
  s_mov_b32 s60, s16
  s_mov_b32 s61, s17
  s_mov_b32 s62, 12800000
  s_mov_b32 s63, 0x20000
  s_add_u32 s48, s34, 67108864
  s_addc_u32 s49, s35, 0
  s_mov_b32 s50, 25600000
  s_mov_b32 s51, 0x20000
K2_ROUND:
  v_and_b32 v8, 1, v0
  v_cmp_eq_u32 vcc, 0, v8
  v_mov_b32 v7, 0xffff00
  v_mov_b32 v85, 0
  v_mov_b32 v86, 0
  v_mov_b32 v87, 0
  v_cndmask_b32 v84, 0, v7, vcc
  v_lshlrev_b32 v8, 4, v0
  ds_write_b128 v8, v[84:87] offset:2176
  ds_write_b128 v8, v[84:87] offset:6272
  ds_write_b128 v8, v[84:87] offset:10368
  ds_write_b128 v8, v[84:87] offset:14464
  ds_write_b128 v8, v[84:87] offset:18560
  v_and_b32 v8, 63, v0
  v_lshlrev_b32 v10, 4, v8
  ds_write_b128 v10, v[84:87] offset:42112
  v_lshlrev_b32 v9, 3, v8
  v_lshlrev_b32 v11, 2, v8
  ds_write_b64 v9, v[86:87] offset:0
  ds_write_b32 v11, v86 offset:512
  v_mov_b32 v88, -1
  v_mov_b32 v89, -1
  ds_write_b64 v9, v[88:89] offset:768
  ds_write_b32 v11, v88 offset:1280
  v_and_b32 v10, 31, v0
  v_lshlrev_b32 v10, 2, v10
  ds_write_b32 v10, v85 offset:2048
  s_waitcnt vmcnt(0)
  s_or_b32 s4, s64, s68
  s_or_b32 s4, s4, s12
  s_cmp_lg_u32 s4, 0
  s_cselect_b32 s3, 1, 0
  s_cbranch_scc1 K2_NOBWW
  ds_write_b128 v39, v[16:19] offset:22656
  ds_write_b128 v39, v[20:23] offset:23680
K2_NOBWW:
  v_cmp_gt_u32 vcc, 60, v8
  s_nop 1
  v_cndmask_b32 v6, 0, v6, vcc
  v_mul_u32_u24 v8, 6668, v8
  v_and_b32 v9, 0xffff, v6
  v_add_u32 v8, v8, v9
  v_lshrrev_b32 v9, 16, v6
  s_add_u32 s4, s65, s68
  v_add_lshl_u32 v8, v8, s4, 5
  v_mov_b32 v7, 0xfffff000
  s_cmp_lg_u32 s64, 0
  s_cbranch_scc1 K2_KEEPP
  v_cmp_lt_u32 s[74:75], s4, v9
  s_add_u32 s4, s4, 4
  v_cmp_lt_u32 s[76:77], s4, v9
  s_add_u32 s4, s4, 4
  v_cmp_lt_u32 s[78:79], s4, v9
  s_add_u32 s4, s4, 4
  v_cmp_lt_u32 s[86:87], s4, v9
  s_add_u32 s4, s4, 4
  s_add_u32 s4, s68, 12
  v_cmp_lt_u32 vcc, s4, v9
  s_bcnt1_i32_b64 s4, vcc
  s_cmp_le_u32 s4, 3
  s_cselect_b32 s7, 16, 12
  s_mov_b32 s57, s7
  s_cselect_b64 s[86:87], s[86:87], 0
K2_KEEPP:
  v_cndmask_b32 v10, v7, v8, s[74:75]
  buffer_load_dwordx4 v[40:43], v10, s[52:55], 0 offen offset:0
  buffer_load_dwordx4 v[44:47], v10, s[52:55], 0 offen offset:16
  s_cmp_eq_u64 s[76:77], 0
  s_cbranch_scc1 K2_SKR1
  v_cndmask_b32 v10, v7, v8, s[76:77]
  buffer_load_dwordx4 v[48:51], v10, s[52:55], 0 offen offset:128
  buffer_load_dwordx4 v[52:55], v10, s[52:55], 0 offen offset:144
K2_SKR1:
  s_cmp_eq_u64 s[78:79], 0
  s_cbranch_scc1 K2_SKR2
  v_cndmask_b32 v10, v7, v8, s[78:79]
  buffer_load_dwordx4 v[56:59], v10, s[52:55], 0 offen offset:256
  buffer_load_dwordx4 v[60:63], v10, s[52:55], 0 offen offset:272
K2_SKR2:
  s_cmp_eq_u64 s[86:87], 0
  s_cbranch_scc1 K2_SKR3
  v_cndmask_b32 v10, v7, v8, s[86:87]
  buffer_load_dwordx4 v[64:67], v10, s[52:55], 0 offen offset:384
  buffer_load_dwordx4 v[68:71], v10, s[52:55], 0 offen offset:400
K2_SKR3:
  v_and_b32 v8, 63, v0
  s_waitcnt lgkmcnt(0)
  s_bcnt1_i32_b64 s6, s[8:9]
  s_bcnt1_i32_b64 s15, s[10:11]
  s_add_u32 s7, s15, s6
  s_bcnt1_i32_b64 s15, s[100:101]
  s_add_u32 s15, s15, s7
  s_cmp_eq_u32 s15, 0
  s_cbranch_scc1 K2_END
  s_sub_u32 s67, s15, s12
  s_min_u32 s67, s67, 60
  s_cmp_lg_u32 s65, 0
  s_cbranch_scc1 K2_NONODE
  v_mbcnt_lo_u32_b32 v9, s8, 0
  v_mbcnt_hi_u32_b32 v9, s9, v9
  v_mbcnt_lo_u32_b32 v10, s10, 0
  v_mbcnt_hi_u32_b32 v10, s11, v10
  v_mbcnt_lo_u32_b32 v14, s100, 0
  v_mbcnt_hi_u32_b32 v14, s101, v14
  s_sub_u32 s4, s7, s12
  v_add_u32 v14, s4, v14
  v_cmp_gt_u32 vcc, 60, v14
  v_lshlrev_b32 v14, 2, v14
  v_add_u32 v11, 128, v8
  s_and_b64 exec, vcc, s[100:101]
  ds_write_b32 v14, v11 offset:1536
  s_mov_b64 exec, -1
  s_sub_u32 s4, s6, s12
  v_subrev_u32 v9, s12, v9
  v_add_u32 v10, s4, v10
  v_cmp_gt_u32 vcc, 60, v9
  v_cmp_gt_u32 s[6:7], 60, v10
  v_lshlrev_b32 v9, 2, v9
  v_lshlrev_b32 v10, 2, v10
  v_add_u32 v11, 64, v8
  s_and_b64 exec, vcc, s[8:9]
  ds_write_b32 v9, v8 offset:1536
  s_and_b64 exec, s[6:7], s[10:11]
  ds_write_b32 v10, v11 offset:1536
  s_mov_b64 exec, -1
  v_lshlrev_b32 v9, 2, v8
  ds_read_b32 v13, v9 offset:1536
K2_NONODE:
  s_waitcnt lgkmcnt(0)
  s_barrier
  s_cmp_lg_u32 s3, 0
  s_cbranch_scc1 K2_NOBWR
  v_lshlrev_b32 v11, 4, v8
  ds_read_b128 v[16:19], v11 offset:22656
  ds_read_b128 v[20:23], v11 offset:23680
  ds_read_b128 v[24:27], v11 offset:24704
  ds_read_b128 v[28:31], v11 offset:25728
  ds_read_b128 v[32:35], v11 offset:26752
  ds_read_b128 v[36:39], v11 offset:27776
K2_NOBWR:
  v_mov_b32 v7, 32
  s_waitcnt vmcnt(0)
  v_lshrrev_b32 v92, 16, v40
  v_lshlrev_b32 v92, 2, v92
  s_mov_b64 exec, s[74:75]
  ds_add_rtn_u32 v97, v92, v7 offset:0
  s_mov_b64 exec, -1
  v_lshrrev_b32 v93, 16, v48
  v_lshlrev_b32 v93, 2, v93
  s_mov_b64 exec, s[76:77]
  ds_add_rtn_u32 v98, v93, v7 offset:0
  s_mov_b64 exec, -1
  v_lshrrev_b32 v94, 16, v56
  v_lshlrev_b32 v94, 2, v94
  s_mov_b64 exec, s[78:79]
  ds_add_rtn_u32 v99, v94, v7 offset:0
  s_mov_b64 exec, -1
  v_lshrrev_b32 v95, 16, v64
  v_lshlrev_b32 v95, 2, v95
  s_mov_b64 exec, s[86:87]
  ds_add_rtn_u32 v100, v95, v7 offset:0
  s_mov_b64 exec, -1
  v_and_b32 v40, 0xffff, v40
  v_lshlrev_b32 v40, 8, v40
  v_and_b32 v48, 0xffff, v48
  v_lshlrev_b32 v48, 8, v48
  v_and_b32 v56, 0xffff, v56
  v_lshlrev_b32 v56, 8, v56
  v_and_b32 v64, 0xffff, v64
  v_lshlrev_b32 v64, 8, v64
  s_waitcnt lgkmcnt(0)
  s_barrier
  s_cmp_lg_u32 s65, 0
  s_cbranch_scc1 K2_NORANK
  v_min_u32 v13, 191, v13
  v_lshlrev_b32 v9, 2, v13
  ds_read_b32 v10, v9 offset:0
  v_cmp_gt_u32 s[26:27], s67, v8
  v_mov_b32 v7, 1
  v_and_b32 v108, 15, v8
  v_sub_u32 v108, 15, v108
  v_lshlrev_b32 v108, 2, v108
  s_waitcnt lgkmcnt(0)
  v_min_u32 v10, 1024, v10
  v_cndmask_b32 v10, 0, v10, s[26:27]
  v_cmp_lt_u32 vcc, 160, v10
  s_bcnt1_i32_b64 s73, vcc
  v_add_u32 v11, 608, v10
  v_lshrrev_b32 v11, 7, v11
  v_lshrrev_b32 v14, 5, v10
  v_cndmask_b32 v11, v14, v11, vcc
  v_lshlrev_b32 v11, 2, v11
  s_mov_b64 exec, s[26:27]
  ds_add_rtn_u32 v14, v11, v7 offset:2048
  s_mov_b64 exec, -1
  ds_read_b32 v109, v108 offset:2048
  v_sub_u32 v11, 60, v11
  s_waitcnt lgkmcnt(0)
  v_mov_b32 v110, v109
  s_nop 1
  v_add_u32_dpp v110, v110, v110 row_shr:1 row_mask:0xf bank_mask:0xf
  s_nop 1
  v_add_u32_dpp v110, v110, v110 row_shr:2 row_mask:0xf bank_mask:0xf
  s_nop 1
  v_add_u32_dpp v110, v110, v110 row_shr:4 row_mask:0xf bank_mask:0xf
  s_nop 1
  v_add_u32_dpp v110, v110, v110 row_shr:8 row_mask:0xf bank_mask:0xf
  v_sub_u32 v110, v110, v109
  ds_bpermute_b32 v9, v11, v110
  v_lshl_or_b32 v7, v13, 16, v10
  v_subrev_u32 v111, s73, v8
  v_cmp_gt_u32 s[32:33], s73, v8
  v_and_b32 v111, 7, v111
  v_and_b32 v112, 1, v8
  v_cndmask_b32 v111, v111, v112, s[32:33]
  v_cmp_eq_u32 s[6:7], 0, v111
  s_and_b64 s[6:7], s[6:7], s[26:27]
  v_lshlrev_b32 v111, 5, v111
  s_waitcnt lgkmcnt(0)
  v_add_u32 v9, v9, v14
  v_cndmask_b32 v9, v8, v9, s[26:27]
  v_lshlrev_b32 v9, 2, v9
  ds_permute_b32 v13, v9, v7
  s_waitcnt lgkmcnt(0)
  v_and_b32 v10, 0xffff, v13
  v_add_u32 v14, 96, v10
  v_and_b32 v14, 0xffffff80, v14
  v_lshlrev_b32 v14, 1, v14
  v_lshlrev_b32 v10, 3, v10
  v_cndmask_b32 v10, v10, v14, s[32:33]
  v_add_u32 v10, 256, v10
  v_cndmask_b32 v10, 0, v10, s[6:7]
  v_mov_b32 v14, v10
  s_nop 1
  v_add_u32_dpp v14, v14, v14 row_shr:1 row_mask:0xf bank_mask:0xf
  s_nop 1
  v_add_u32_dpp v14, v14, v14 row_shr:2 row_mask:0xf bank_mask:0xf
  s_nop 1
  v_add_u32_dpp v14, v14, v14 row_shr:4 row_mask:0xf bank_mask:0xf
  s_nop 1
  v_add_u32_dpp v14, v14, v14 row_shr:8 row_mask:0xf bank_mask:0xf
  s_nop 1
  v_add_u32_dpp v14, v14, v14 row_bcast:15 row_mask:0xa bank_mask:0xf
  s_nop 1
  v_add_u32_dpp v14, v14, v14 row_bcast:31 row_mask:0xc bank_mask:0xf
  s_nop 0
  v_readlane_b32 s4, v14, 63
  v_sub_u32 v14, v14, v10
  v_lshl_or_b32 v5, v10, 16, v14
  v_lshlrev_b32 v9, 2, v8
  ds_write_b32 v9, v5 offset:1792
  s_cmp_le_u32 s4, 20480
  s_cbranch_scc1 K2_NOPRE2
  v_lshlrev_b32 v7, 4, v8
  ds_write_b128 v7, v[84:87] offset:22656
  ds_write_b128 v7, v[84:87] offset:23680
  ds_write_b128 v7, v[84:87] offset:24704
  ds_write_b128 v7, v[84:87] offset:25728
  ds_write_b128 v7, v[84:87] offset:26752
  ds_write_b128 v7, v[84:87] offset:27776
  ds_write_b128 v7, v[84:87] offset:28800
  ds_write_b128 v7, v[84:87] offset:29824
  ds_write_b128 v7, v[84:87] offset:30848
  ds_write_b128 v7, v[84:87] offset:31872
  ds_write_b128 v7, v[84:87] offset:32896
  ds_write_b128 v7, v[84:87] offset:33920
  ds_write_b128 v7, v[84:87] offset:34944
  ds_write_b128 v7, v[84:87] offset:35968
  ds_write_b128 v7, v[84:87] offset:36992
  ds_write_b128 v7, v[84:87] offset:38016
  ds_write_b128 v7, v[84:87] offset:39040
  ds_write_b128 v7, v[84:87] offset:40064
  ds_write_b128 v7, v[84:87] offset:41088
K2_NOPRE2:
  v_cndmask_b32 v11, 0, v14, s[6:7]
  s_nop 1
  v_max_u32_dpp v11, v11, v11 row_shr:1 row_mask:0xf bank_mask:0xf
  s_nop 1
  v_max_u32_dpp v11, v11, v11 row_shr:2 row_mask:0xf bank_mask:0xf
  s_nop 1
  v_max_u32_dpp v11, v11, v11 row_shr:4 row_mask:0xf bank_mask:0xf
  s_nop 1
  v_max_u32_dpp v11, v11, v11 row_bcast:15 row_mask:0xa bank_mask:0xf
  s_nop 1
  v_max_u32_dpp v11, v11, v11 row_bcast:31 row_mask:0xc bank_mask:0xf
  v_add_u32 v11, v11, v111
  v_mov_b32 v7, 0x30000
  v_mov_b32 v9, 0x10000
  v_cndmask_b32 v7, v7, v9, s[32:33]
  v_or_b32 v7, v7, v11
  v_lshrrev_b32 v9, 16, v13
  v_lshlrev_b32 v10, 2, v9
  v_add_u32 v9, s66, v9
  v_lshlrev_b32 v9, 8, v9
  v_mov_b32 v14, 0x80000000
  v_mov_b32 v109, 0xc0000000
  v_cndmask_b32 v14, v14, v109, s[32:33]
  v_or_b32 v9, v14, v9
  s_mov_b64 exec, s[26:27]
  ds_write_b32 v10, v7 offset:768
  ds_write_b32 v11, v9 offset:2176
  s_mov_b64 exec, -1
K2_NORANK:
  s_waitcnt lgkmcnt(0)
  s_barrier
  v_lshlrev_b32 v9, 2, v8
  ds_read_b32 v5, v9 offset:1792
  ds_read_b32 v102, v92 offset:768
  ds_read_b32 v103, v93 offset:768
  ds_read_b32 v104, v94 offset:768
  ds_read_b32 v105, v95 offset:768
  s_waitcnt lgkmcnt(4)
  v_readlane_b32 s4, v5, 63
  v_and_b32 v14, 0xffff, v5
  v_lshrrev_b32 v10, 16, v5
  v_lshl_add_u32 v9, v14, 1, v10
  v_mul_u32_u24 v9, 4, v9
  s_and_b32 s5, s4, 0xffff
  s_lshr_b32 s4, s4, 16
  s_add_u32 s4, s4, s5
  s_lshl_b32 s4, s4, 1
  s_mul_i32 s5, s4, s65
  s_add_u32 s6, s5, s4
  v_cmp_le_u32 s[82:83], s5, v9
  v_cmp_gt_u32 vcc, s6, v9
  s_and_b64 s[82:83], s[82:83], vcc
  v_cmp_ne_u32 vcc, 0, v10
  s_and_b64 s[82:83], s[82:83], vcc
  s_waitcnt lgkmcnt(3)
  v_cmp_le_i32 vcc, 0, v102
  s_and_b64 s[74:75], s[74:75], vcc
  v_cmp_gt_u32 vcc, 1024, v97
  s_and_b64 s[18:19], s[74:75], vcc
  s_andn2_b64 s[74:75], s[74:75], vcc
  v_lshrrev_b32 v8, 16, v102
  v_lshlrev_b32 v97, v8, v97
  v_and_b32 v102, 0xffff, v102
  v_add_u32 v102, v102, v97
  s_mov_b64 exec, s[18:19]
  ds_write_b128 v102, v[40:43] offset:2432
  ds_write_b128 v102, v[44:47] offset:2448
  s_mov_b64 exec, -1
  s_waitcnt lgkmcnt(2)
  v_cmp_le_i32 vcc, 0, v103
  s_and_b64 s[76:77], s[76:77], vcc
  v_cmp_gt_u32 vcc, 1024, v98
  s_and_b64 s[20:21], s[76:77], vcc
  s_andn2_b64 s[76:77], s[76:77], vcc
  v_lshrrev_b32 v8, 16, v103
  v_lshlrev_b32 v98, v8, v98
  v_and_b32 v103, 0xffff, v103
  v_add_u32 v103, v103, v98
  s_mov_b64 exec, s[20:21]
  ds_write_b128 v103, v[48:51] offset:2432
  ds_write_b128 v103, v[52:55] offset:2448
  s_mov_b64 exec, -1
  s_waitcnt lgkmcnt(1)
  v_cmp_le_i32 vcc, 0, v104
  s_and_b64 s[78:79], s[78:79], vcc
  v_cmp_gt_u32 vcc, 1024, v99
  s_and_b64 s[22:23], s[78:79], vcc
  s_andn2_b64 s[78:79], s[78:79], vcc
  v_lshrrev_b32 v8, 16, v104
  v_lshlrev_b32 v99, v8, v99
  v_and_b32 v104, 0xffff, v104
  v_add_u32 v104, v104, v99
  s_mov_b64 exec, s[22:23]
  ds_write_b128 v104, v[56:59] offset:2432
  ds_write_b128 v104, v[60:63] offset:2448
  s_mov_b64 exec, -1
  s_waitcnt lgkmcnt(0)
  v_cmp_le_i32 vcc, 0, v105
  s_and_b64 s[86:87], s[86:87], vcc
  v_cmp_gt_u32 vcc, 1024, v100
  s_and_b64 s[88:89], s[86:87], vcc
  s_andn2_b64 s[86:87], s[86:87], vcc
  v_lshrrev_b32 v8, 16, v105
  v_lshlrev_b32 v100, v8, v100
  v_and_b32 v105, 0xffff, v105
  v_add_u32 v105, v105, v100
  s_mov_b64 exec, s[88:89]
  ds_write_b128 v105, v[64:67] offset:2432
  ds_write_b128 v105, v[68:71] offset:2448
  s_mov_b64 exec, -1
  s_mov_b64 s[4:5], s[74:75]
  s_or_b64 s[4:5], s[4:5], s[76:77]
  s_or_b64 s[4:5], s[4:5], s[78:79]
  s_or_b64 s[4:5], s[4:5], s[86:87]
  s_cmp_eq_u64 s[4:5], 0
  s_cbranch_scc1 K2_NOPEND
  v_mov_b32 v8, 2112
  v_mov_b32 v9, 1
  ds_write_b32 v8, v9
K2_NOPEND:
  v_mov_b32 v92, 0
  v_mov_b32 v93, 0
  v_mov_b32 v94, 0
  v_mov_b32 v95, 0
  v_mov_b32 v96, 0
  v_mov_b32 v97, 0
  v_mov_b32 v98, 0
  v_mov_b32 v99, 0
  v_mov_b32 v100, 0
  v_mov_b32 v101, 0
  v_mov_b32 v102, 0
  v_mov_b32 v103, 0
  v_mov_b32 v104, 0
  v_mov_b32 v105, 0
  v_mov_b32 v106, 0
  v_mov_b32 v107, 0
  v_mov_b32 v108, 0
  v_mov_b32 v109, 0
  v_mov_b32 v110, 0
  v_mov_b32 v111, 0
  v_mov_b32 v112, 0
  v_mov_b32 v113, 0
  v_mov_b32 v114, 0
  v_mov_b32 v115, 0
  v_mov_b32 v116, 0
  v_mov_b32 v117, 0
  v_mov_b32 v118, 0
  v_mov_b32 v119, 0
  v_mov_b32 v120, 0
  v_mov_b32 v121, 0
  v_mov_b32 v122, 0
  v_mov_b32 v123, 0
  v_mov_b32 v124, 0
  v_mov_b32 v125, 0
  v_mov_b32 v126, 0
  v_mov_b32 v127, 0
  v_mov_b32 v128, 0
  v_mov_b32 v129, 0
  v_mov_b32 v130, 0
  v_mov_b32 v131, 0
  v_mov_b32 v132, 0
  v_mov_b32 v133, 0
  v_mov_b32 v134, 0
  v_mov_b32 v135, 0
  v_mov_b32 v136, 0
  v_mov_b32 v137, 0
  v_mov_b32 v138, 0
  v_mov_b32 v139, 0
  v_mov_b32 v140, 0
  v_mov_b32 v141, 0
  v_mov_b32 v142, 0
  v_mov_b32 v143, 0
  v_mov_b32 v144, 0
  v_mov_b32 v145, 0
  v_mov_b32 v146, 0
  v_mov_b32 v147, 0
  v_mov_b32 v148, 0
  v_mov_b32 v149, 0
  v_mov_b32 v150, 0
  v_mov_b32 v151, 0
  s_waitcnt lgkmcnt(0)
  s_barrier
  v_mov_b32 v8, 2112
  ds_read_b32 v9, v8
  v_lshrrev_b32 v10, 16, v6
  s_add_u32 s4, s68, s57
  v_cmp_lt_u32 vcc, s4, v10
  s_or_b32 s27, s64, s68
  s_or_b32 s26, vcc_lo, vcc_hi
  s_waitcnt lgkmcnt(0)
  v_readfirstlane_b32 s64, v9
  s_or_b32 s26, s26, s64
  s_cmp_eq_u64 s[82:83], 0
  s_cbranch_scc1 K2_QDONE
  s_ff1_i32_b64 s69, s[82:83]
  s_flbit_i32_b64 s4, s[82:83]
  s_sub_u32 s4, 63, s4
  v_readlane_b32 s5, v5, s69
  v_readlane_b32 s6, v5, s4
  s_bitset0_b64 s[82:83], s69
  s_and_b32 s70, s5, 0xffff
  s_add_u32 s70, s70, 2176
  s_lshr_b32 s71, s5, 16
  s_add_u32 s71, s71, s70
  s_and_b32 s84, s6, 0xffff
  s_lshr_b32 s6, s6, 16
  s_add_u32 s84, s84, s6
  s_add_u32 s84, s84, 2176
  s_mov_b32 s85, 0
  s_mov_b32 s72, 0
  s_mov_b32 s73, 0
  s_mov_b32 s33, 0
  s_add_u32 s4, s70, 0
  s_cmp_lt_u32 s4, s84
  s_cselect_b32 s4, s4, 42880
  v_add_u32 v11, s4, v2
  ds_read_b32 v72, v11
  s_add_u32 s4, s70, 256
  s_cmp_lt_u32 s4, s84
  s_cselect_b32 s4, s4, 42880
  v_add_u32 v11, s4, v2
  ds_read_b32 v73, v11
  s_add_u32 s4, s70, 512
  s_cmp_lt_u32 s4, s84
  s_cselect_b32 s4, s4, 42880
  v_add_u32 v11, s4, v2
  ds_read_b32 v74, v11
  s_waitcnt lgkmcnt(2)
  s_add_u32 s4, s70, 0
  s_cmp_lt_u32 s4, s84
  s_cbranch_scc1 K2_IR1
  s_add_u32 s33, s33, 1
  s_branch K2_IE1
K2_IR1:
  v_readfirstlane_b32 s4, v72
  v_mad_u32_u24 v8, v72, 5, v1
  s_cmp_lt_i32 s4, 0
  s_cbranch_scc1 K2_II1
  v_cmp_ne_u32 vcc, 0xffff00, v72
  s_or_b32 vcc_lo, vcc_lo, 1
  s_mov_b64 exec, vcc
  buffer_load_dwordx4 v[92:95], v8, s[40:43], 0 offen offset:0
  buffer_load_dwordx4 v[96:99], v8, s[40:43], 0 offen offset:256
  buffer_load_dwordx4 v[100:103], v8, s[40:43], 0 offen offset:512
  buffer_load_dwordx4 v[104:107], v8, s[40:43], 0 offen offset:768
  buffer_load_dwordx4 v[108:111], v8, s[40:43], 0 offen offset:1024
  s_mov_b64 exec, -1
  s_branch K2_IE1
K2_II1:
  v_lshl_add_u32 v9, v72, 2, v1
  v_mov_b32 v8, 0xfffff000
  buffer_load_dwordx4 v[92:95], v9, s[60:63], 0 offen
  buffer_load_dwordx4 v[100:103], v9, s[60:63], 0 offen offset:256
  buffer_load_dwordx4 v[104:107], v9, s[60:63], 0 offen offset:512
  buffer_load_dwordx4 v[108:111], v9, s[60:63], 0 offen offset:768
  s_mov_b64 exec, 1
  buffer_load_dword v96, v8, s[40:43], 0 offen
  s_mov_b64 exec, -1
K2_IE1:
  s_waitcnt lgkmcnt(1)
  s_add_u32 s4, s70, 256
  s_cmp_lt_u32 s4, s84
  s_cbranch_scc1 K2_IR2
  s_add_u32 s33, s33, 1
  s_branch K2_IE2
K2_IR2:
  v_readfirstlane_b32 s4, v73
  v_mad_u32_u24 v8, v73, 5, v1
  s_cmp_lt_i32 s4, 0
  s_cbranch_scc1 K2_II2
  v_cmp_ne_u32 vcc, 0xffff00, v73
  s_or_b32 vcc_lo, vcc_lo, 1
  s_mov_b64 exec, vcc
  buffer_load_dwordx4 v[112:115], v8, s[40:43], 0 offen offset:0
  buffer_load_dwordx4 v[116:119], v8, s[40:43], 0 offen offset:256
  buffer_load_dwordx4 v[120:123], v8, s[40:43], 0 offen offset:512
  buffer_load_dwordx4 v[124:127], v8, s[40:43], 0 offen offset:768
  buffer_load_dwordx4 v[128:131], v8, s[40:43], 0 offen offset:1024
  s_mov_b64 exec, -1
  s_branch K2_IE2
K2_II2:
  v_lshl_add_u32 v9, v73, 2, v1
  v_mov_b32 v8, 0xfffff000
  buffer_load_dwordx4 v[112:115], v9, s[60:63], 0 offen
  buffer_load_dwordx4 v[120:123], v9, s[60:63], 0 offen offset:256
  buffer_load_dwordx4 v[124:127], v9, s[60:63], 0 offen offset:512
  buffer_load_dwordx4 v[128:131], v9, s[60:63], 0 offen offset:768
  s_mov_b64 exec, 1
  buffer_load_dword v116, v8, s[40:43], 0 offen
  s_mov_b64 exec, -1
K2_IE2:
  s_waitcnt lgkmcnt(0)
  s_add_u32 s4, s70, 512
  s_cmp_lt_u32 s4, s84
  s_cbranch_scc1 K2_IR3
  s_add_u32 s33, s33, 1
  s_branch K2_IE3
K2_IR3:
  v_readfirstlane_b32 s4, v74
  v_mad_u32_u24 v8, v74, 5, v1
  s_cmp_lt_i32 s4, 0
  s_cbranch_scc1 K2_II3
  v_cmp_ne_u32 vcc, 0xffff00, v74
  s_or_b32 vcc_lo, vcc_lo, 1
  s_mov_b64 exec, vcc
  buffer_load_dwordx4 v[132:135], v8, s[40:43], 0 offen offset:0
  buffer_load_dwordx4 v[136:139], v8, s[40:43], 0 offen offset:256
  buffer_load_dwordx4 v[140:143], v8, s[40:43], 0 offen offset:512
  buffer_load_dwordx4 v[144:147], v8, s[40:43], 0 offen offset:768
  buffer_load_dwordx4 v[148:151], v8, s[40:43], 0 offen offset:1024
  s_mov_b64 exec, -1
  s_branch K2_IE3
K2_II3:
  v_lshl_add_u32 v9, v74, 2, v1
  v_mov_b32 v8, 0xfffff000
  buffer_load_dwordx4 v[132:135], v9, s[60:63], 0 offen
  buffer_load_dwordx4 v[140:143], v9, s[60:63], 0 offen offset:256
  buffer_load_dwordx4 v[144:147], v9, s[60:63], 0 offen offset:512
  buffer_load_dwordx4 v[148:151], v9, s[60:63], 0 offen offset:768
  s_mov_b64 exec, 1
  buffer_load_dword v136, v8, s[40:43], 0 offen
  s_mov_b64 exec, -1
K2_IE3:
K2_G0:
  v_add_u32 v8, s70, v2
  v_mad_u32_u24 v9, s70, v3, v4
  ds_read_b128 v[88:91], v8
  ds_read2_b64 v[84:87], v9 offset0:2 offset1:6
  ds_read2_b32 v[152:153], v8 offset0:6 offset1:6
  s_add_u32 s4, s70, 768
  s_cmp_lt_u32 s4, s84
  s_cselect_b32 s4, s4, 42880
  v_add_u32 v11, s4, v2
  ds_read_b32 v7, v11
  s_add_u32 s70, s70, 256
  s_waitcnt lgkmcnt(3)
  v_readfirstlane_b32 s5, v88
  s_cmp_lt_i32 s5, 0
  s_cbranch_scc0 K2_N0
  s_mov_b32 s72, s5
  v_readlane_b32 s73, v88, 8
  s_cmp_eq_u32 s33, 0
  s_cbranch_scc1 K2_W4_N
  s_cmp_eq_u32 s33, 1
  s_cbranch_scc0 K2_W4_T1
  s_waitcnt vmcnt(5)
  s_branch K2_W4_E
K2_W4_T1:
  s_waitcnt vmcnt(0)
  s_branch K2_W4_E
K2_W4_N:
  s_cmp_eq_u32 s85, 0
  s_cbranch_scc1 K2_W4_0
  s_bcnt1_i32_b32 s4, s85
  s_cmp_eq_u32 s4, 1
  s_cbranch_scc1 K2_W4_1
  s_cmp_eq_u32 s4, 2
  s_cbranch_scc1 K2_W4_2
  s_waitcnt vmcnt(22)
  s_branch K2_W4_E
K2_W4_2:
  s_waitcnt vmcnt(18)
  s_branch K2_W4_E
K2_W4_1:
  s_waitcnt vmcnt(14)
  s_branch K2_W4_E
K2_W4_0:
  s_waitcnt vmcnt(10)
K2_W4_E:
  v_lshl_add_u32 v15, v88, 2, v1
  s_cmp_eq_u32 s27, 0
  s_cbranch_scc1 K2_I00
  v_lshlrev_b32 v8, 1, v15
  buffer_load_dwordx4 v[40:43], v8, s[48:51], 0 offen offset:0 sc0 sc1
  buffer_load_dwordx4 v[44:47], v8, s[48:51], 0 offen offset:16 sc0 sc1
  buffer_load_dwordx4 v[48:51], v8, s[48:51], 0 offen offset:512 sc0 sc1
  buffer_load_dwordx4 v[52:55], v8, s[48:51], 0 offen offset:528 sc0 sc1
  buffer_load_dwordx4 v[56:59], v8, s[48:51], 0 offen offset:1024 sc0 sc1
  buffer_load_dwordx4 v[60:63], v8, s[48:51], 0 offen offset:1040 sc0 sc1
  buffer_load_dwordx4 v[64:67], v8, s[48:51], 0 offen offset:1536 sc0 sc1
  buffer_load_dwordx4 v[68:71], v8, s[48:51], 0 offen offset:1552 sc0 sc1
  s_waitcnt vmcnt(0) lgkmcnt(0)
  s_branch K2_C0
K2_I00:
  v_lshlrev_b32 v40, 16, v92
  v_and_b32 v42, v12, v92
  v_lshlrev_b32 v41, 16, v93
  v_and_b32 v43, v12, v93
  v_lshlrev_b32 v44, 16, v94
  v_and_b32 v46, v12, v94
  v_lshlrev_b32 v45, 16, v95
  v_and_b32 v47, v12, v95
  v_lshlrev_b32 v48, 16, v100
  v_and_b32 v50, v12, v100
  v_lshlrev_b32 v49, 16, v101
  v_and_b32 v51, v12, v101
  v_lshlrev_b32 v52, 16, v102
  v_and_b32 v54, v12, v102
  v_lshlrev_b32 v53, 16, v103
  v_and_b32 v55, v12, v103
  v_lshlrev_b32 v56, 16, v104
  v_and_b32 v58, v12, v104
  v_lshlrev_b32 v57, 16, v105
  v_and_b32 v59, v12, v105
  v_lshlrev_b32 v60, 16, v106
  v_and_b32 v62, v12, v106
  v_lshlrev_b32 v61, 16, v107
  v_and_b32 v63, v12, v107
  v_lshlrev_b32 v64, 16, v108
  v_and_b32 v66, v12, v108
  v_lshlrev_b32 v65, 16, v109
  v_and_b32 v67, v12, v109
  v_lshlrev_b32 v68, 16, v110
  v_and_b32 v70, v12, v110
  v_lshlrev_b32 v69, 16, v111
  v_and_b32 v71, v12, v111
  s_waitcnt lgkmcnt(0)
  s_branch K2_C0
K2_N0:
  s_waitcnt lgkmcnt(2)
  v_mfma_f32_16x16x32_bf16 v[72:75], v[84:87], v[16:19], 0
  v_mfma_f32_16x16x32_bf16 v[76:79], v[84:87], v[24:27], 0
  v_mfma_f32_16x16x32_bf16 v[80:83], v[84:87], v[32:35], 0
  s_cmp_eq_u32 s33, 0
  s_cbranch_scc1 K2_W5_N
  s_cmp_eq_u32 s33, 1
  s_cbranch_scc0 K2_W5_T1
  s_waitcnt vmcnt(5)
  s_branch K2_W5_E
K2_W5_T1:
  s_waitcnt vmcnt(0)
  s_branch K2_W5_E
K2_W5_N:
  s_cmp_eq_u32 s85, 0
  s_cbranch_scc1 K2_W5_0
  s_bcnt1_i32_b32 s4, s85
  s_cmp_eq_u32 s4, 1
  s_cbranch_scc1 K2_W5_1
  s_cmp_eq_u32 s4, 2
  s_cbranch_scc1 K2_W5_2
  s_waitcnt vmcnt(22)
  s_branch K2_W5_E
K2_W5_2:
  s_waitcnt vmcnt(18)
  s_branch K2_W5_E
K2_W5_1:
  s_waitcnt vmcnt(14)
  s_branch K2_W5_E
K2_W5_0:
  s_waitcnt vmcnt(10)
K2_W5_E:
  s_waitcnt lgkmcnt(0)
  v_lshlrev_b32 v8, 16, v96
  v_lshlrev_b32 v9, 16, v97
  v_and_b32 v96, v12, v96
  v_and_b32 v97, v12, v97
  v_lshlrev_b32 v10, 16, v92
  v_lshlrev_b32 v11, 16, v93
  v_and_b32 v92, v12, v92
  v_and_b32 v93, v12, v93
  v_pk_mul_f32 v[80:81], v[80:81], v[8:9]
  v_pk_mul_f32 v[82:83], v[82:83], v[96:97]
  v_pk_mul_f32 v[72:73], v[72:73], v[152:153]
  v_pk_mul_f32 v[74:75], v[74:75], v[152:153]
  v_pk_mul_f32 v[76:77], v[76:77], v[152:153]
  v_pk_mul_f32 v[78:79], v[78:79], v[152:153]
  v_pk_fma_f32 v[40:41], v[72:73], v[10:11], v[40:41]
  v_pk_fma_f32 v[42:43], v[74:75], v[92:93], v[42:43]
  v_lshlrev_b32 v10, 16, v100
  v_lshlrev_b32 v11, 16, v101
  v_and_b32 v100, v12, v100
  v_and_b32 v101, v12, v101
  v_lshlrev_b32 v8, 16, v104
  v_lshlrev_b32 v9, 16, v105
  v_and_b32 v104, v12, v104
  v_and_b32 v105, v12, v105
  v_fmac_f32 v48, v80, v89
  v_fmac_f32 v49, v81, v89
  v_fmac_f32 v50, v82, v89
  v_fmac_f32 v51, v83, v89
  v_pk_fma_f32 v[48:49], v[76:77], v[10:11], v[48:49]
  v_pk_fma_f32 v[50:51], v[78:79], v[100:101], v[50:51]
  v_lshlrev_b32 v10, 16, v108
  v_lshlrev_b32 v11, 16, v109
  v_and_b32 v108, v12, v108
  v_and_b32 v109, v12, v109
  v_fmac_f32 v56, v80, v90
  v_fmac_f32 v57, v81, v90
  v_fmac_f32 v58, v82, v90
  v_fmac_f32 v59, v83, v90
  v_pk_fma_f32 v[56:57], v[76:77], v[8:9], v[56:57]
  v_pk_fma_f32 v[58:59], v[78:79], v[104:105], v[58:59]
  v_fmac_f32 v64, v80, v91
  v_fmac_f32 v65, v81, v91
  v_fmac_f32 v66, v82, v91
  v_fmac_f32 v67, v83, v91
  v_pk_fma_f32 v[64:65], v[76:77], v[10:11], v[64:65]
  v_pk_fma_f32 v[66:67], v[78:79], v[108:109], v[66:67]
  v_mfma_f32_16x16x32_bf16 v[72:75], v[84:87], v[20:23], 0
  v_mfma_f32_16x16x32_bf16 v[76:79], v[84:87], v[28:31], 0
  v_mfma_f32_16x16x32_bf16 v[80:83], v[84:87], v[36:39], 0
  v_lshlrev_b32 v8, 16, v98
  v_lshlrev_b32 v9, 16, v99
  v_and_b32 v98, v12, v98
  v_and_b32 v99, v12, v99
  v_lshlrev_b32 v10, 16, v94
  v_lshlrev_b32 v11, 16, v95
  v_and_b32 v94, v12, v94
  v_and_b32 v95, v12, v95
  v_pk_mul_f32 v[80:81], v[80:81], v[8:9]
  v_pk_mul_f32 v[82:83], v[82:83], v[98:99]
  v_pk_mul_f32 v[72:73], v[72:73], v[152:153]
  v_pk_mul_f32 v[74:75], v[74:75], v[152:153]
  v_pk_mul_f32 v[76:77], v[76:77], v[152:153]
  v_pk_mul_f32 v[78:79], v[78:79], v[152:153]
  v_pk_fma_f32 v[44:45], v[72:73], v[10:11], v[44:45]
  v_pk_fma_f32 v[46:47], v[74:75], v[94:95], v[46:47]
  v_lshlrev_b32 v10, 16, v102
  v_lshlrev_b32 v11, 16, v103
  v_and_b32 v102, v12, v102
  v_and_b32 v103, v12, v103
  v_lshlrev_b32 v8, 16, v106
  v_lshlrev_b32 v9, 16, v107
  v_and_b32 v106, v12, v106
  v_and_b32 v107, v12, v107
  v_fmac_f32 v52, v80, v89
  v_fmac_f32 v53, v81, v89
  v_fmac_f32 v54, v82, v89
  v_fmac_f32 v55, v83, v89
  v_pk_fma_f32 v[52:53], v[76:77], v[10:11], v[52:53]
  v_pk_fma_f32 v[54:55], v[78:79], v[102:103], v[54:55]
  v_lshlrev_b32 v10, 16, v110
  v_lshlrev_b32 v11, 16, v111
  v_and_b32 v110, v12, v110
  v_and_b32 v111, v12, v111
  v_fmac_f32 v60, v80, v90
  v_fmac_f32 v61, v81, v90
  v_fmac_f32 v62, v82, v90
  v_fmac_f32 v63, v83, v90
  v_pk_fma_f32 v[60:61], v[76:77], v[8:9], v[60:61]
  v_pk_fma_f32 v[62:63], v[78:79], v[106:107], v[62:63]
  v_fmac_f32 v68, v80, v91
  v_fmac_f32 v69, v81, v91
  v_fmac_f32 v70, v82, v91
  v_fmac_f32 v71, v83, v91
  v_pk_fma_f32 v[68:69], v[76:77], v[10:11], v[68:69]
  v_pk_fma_f32 v[70:71], v[78:79], v[110:111], v[70:71]
K2_C0:
  s_add_u32 s4, s70, 512
  s_cmp_lt_u32 s4, s84
  s_cbranch_scc1 K2_IR6
  s_add_u32 s33, s33, 1
  s_branch K2_IE6
K2_IR6:
  v_readfirstlane_b32 s4, v7
  v_mad_u32_u24 v8, v7, 5, v1
  s_cmp_lt_i32 s4, 0
  s_cbranch_scc1 K2_II6
  v_cmp_ne_u32 vcc, 0xffff00, v7
  s_or_b32 vcc_lo, vcc_lo, 1
  s_mov_b64 exec, vcc
  buffer_load_dwordx4 v[92:95], v8, s[40:43], 0 offen offset:0
  buffer_load_dwordx4 v[96:99], v8, s[40:43], 0 offen offset:256
  buffer_load_dwordx4 v[100:103], v8, s[40:43], 0 offen offset:512
  buffer_load_dwordx4 v[104:107], v8, s[40:43], 0 offen offset:768
  buffer_load_dwordx4 v[108:111], v8, s[40:43], 0 offen offset:1024
  s_mov_b64 exec, -1
  s_branch K2_IE6
K2_II6:
  v_lshl_add_u32 v9, v7, 2, v1
  v_mov_b32 v8, 0xfffff000
  buffer_load_dwordx4 v[92:95], v9, s[60:63], 0 offen
  buffer_load_dwordx4 v[100:103], v9, s[60:63], 0 offen offset:256
  buffer_load_dwordx4 v[104:107], v9, s[60:63], 0 offen offset:512
  buffer_load_dwordx4 v[108:111], v9, s[60:63], 0 offen offset:768
  s_mov_b64 exec, 1
  buffer_load_dword v96, v8, s[40:43], 0 offen
  s_mov_b64 exec, -1
K2_IE6:
  s_lshl_b32 s85, s85, 1
  s_and_b32 s85, s85, 7
  s_cmp_lt_u32 s70, s71
  s_cbranch_scc1 K2_G1
  s_ff1_i32_b64 s69, s[82:83]
  s_max_i32 s69, s69, 0
  v_readlane_b32 s5, v5, s69
  s_bitset0_b64 s[82:83], s69
  s_bitcmp1_b32 s72, 30
  s_cbranch_scc1 K2_FW0
  s_or_b32 s85, s85, 1
  s_cmp_eq_u32 s26, 0
  s_cbranch_scc1 K2_F00
  v_lshlrev_b32 v8, 1, v15
  buffer_store_dwordx4 v[40:43], v8, s[48:51], 0 offen offset:0
  buffer_store_dwordx4 v[44:47], v8, s[48:51], 0 offen offset:16
  buffer_store_dwordx4 v[48:51], v8, s[48:51], 0 offen offset:512
  buffer_store_dwordx4 v[52:55], v8, s[48:51], 0 offen offset:528
  buffer_store_dwordx4 v[56:59], v8, s[48:51], 0 offen offset:1024
  buffer_store_dwordx4 v[60:63], v8, s[48:51], 0 offen offset:1040
  buffer_store_dwordx4 v[64:67], v8, s[48:51], 0 offen offset:1536
  buffer_store_dwordx4 v[68:71], v8, s[48:51], 0 offen offset:1552
K2_F00:
  v_cvt_pk_bf16_f32 v72, v40, v42
  v_cvt_pk_bf16_f32 v73, v41, v43
  v_cvt_pk_bf16_f32 v74, v44, v46
  v_cvt_pk_bf16_f32 v75, v45, v47
  buffer_store_dwordx4 v[72:75], v15, s[44:47], 0 offen offset:0 sc1
  v_cvt_pk_bf16_f32 v76, v48, v50
  v_cvt_pk_bf16_f32 v77, v49, v51
  v_cvt_pk_bf16_f32 v78, v52, v54
  v_cvt_pk_bf16_f32 v79, v53, v55
  buffer_store_dwordx4 v[76:79], v15, s[44:47], 0 offen offset:256 sc1
  v_cvt_pk_bf16_f32 v80, v56, v58
  v_cvt_pk_bf16_f32 v81, v57, v59
  v_cvt_pk_bf16_f32 v82, v60, v62
  v_cvt_pk_bf16_f32 v83, v61, v63
  buffer_store_dwordx4 v[80:83], v15, s[44:47], 0 offen offset:512 sc1
  v_cvt_pk_bf16_f32 v84, v64, v66
  v_cvt_pk_bf16_f32 v85, v65, v67
  v_cvt_pk_bf16_f32 v86, v68, v70
  v_cvt_pk_bf16_f32 v87, v69, v71
  buffer_store_dwordx4 v[84:87], v15, s[44:47], 0 offen offset:768 sc1
  s_branch K2_FE0
K2_FW0:
  v_permlane32_swap_b32 v40, v56
  v_permlane32_swap_b32 v41, v57
  v_permlane32_swap_b32 v42, v58
  v_permlane32_swap_b32 v43, v59
  v_permlane32_swap_b32 v44, v60
  v_permlane32_swap_b32 v45, v61
  v_permlane32_swap_b32 v46, v62
  v_permlane32_swap_b32 v47, v63
  v_permlane32_swap_b32 v48, v64
  v_permlane32_swap_b32 v49, v65
  v_permlane32_swap_b32 v50, v66
  v_permlane32_swap_b32 v51, v67
  v_permlane32_swap_b32 v52, v68
  v_permlane32_swap_b32 v53, v69
  v_permlane32_swap_b32 v54, v70
  v_permlane32_swap_b32 v55, v71
  s_lshl_b32 s4, s72, 2
  s_lshl_b32 s6, s73, 2
  v_mov_b32 v10, s4
  v_mov_b32 v9, s6
  v_cndmask_b32 v10, v10, v9, s[28:29]
  v_and_b32 v11, 0xc0, v2
  v_lshl_add_u32 v11, v11, 2, v1
  v_pk_add_f32 v[40:41], v[40:41], v[56:57]
  v_pk_add_f32 v[42:43], v[42:43], v[58:59]
  v_pk_add_f32 v[44:45], v[44:45], v[60:61]
  v_pk_add_f32 v[46:47], v[46:47], v[62:63]
  v_pk_add_f32 v[48:49], v[48:49], v[64:65]
  v_pk_add_f32 v[50:51], v[50:51], v[66:67]
  v_pk_add_f32 v[52:53], v[52:53], v[68:69]
  v_pk_add_f32 v[54:55], v[54:55], v[70:71]
  v_permlane16_swap_b32 v40, v48
  v_permlane16_swap_b32 v41, v49
  v_permlane16_swap_b32 v42, v50
  v_permlane16_swap_b32 v43, v51
  v_permlane16_swap_b32 v44, v52
  v_permlane16_swap_b32 v45, v53
  v_permlane16_swap_b32 v46, v54
  v_permlane16_swap_b32 v47, v55
  v_add_u32 v11, v10, v11
  v_pk_add_f32 v[40:41], v[40:41], v[48:49]
  v_pk_add_f32 v[42:43], v[42:43], v[50:51]
  v_pk_add_f32 v[44:45], v[44:45], v[52:53]
  v_pk_add_f32 v[46:47], v[46:47], v[54:55]
  v_cvt_pk_bf16_f32 v72, v40, v42
  v_cvt_pk_bf16_f32 v73, v41, v43
  v_cvt_pk_bf16_f32 v74, v44, v46
  v_cvt_pk_bf16_f32 v75, v45, v47
  buffer_store_dwordx4 v[72:75], v11, s[44:47], 0 offen sc1
  s_cmp_eq_u32 s26, 0
  s_cbranch_scc1 K2_FE0
  v_lshlrev_b32 v8, 1, v11
  buffer_store_dwordx4 v[40:43], v8, s[48:51], 0 offen offset:0
  buffer_store_dwordx4 v[44:47], v8, s[48:51], 0 offen offset:16
K2_FE0:
  s_lshr_b32 s5, s5, 16
  s_add_u32 s71, s71, s5
  s_cmp_lt_u32 s70, s84
  s_cbranch_scc1 K2_G1
  s_branch K2_QDONE
K2_G1:
  v_add_u32 v8, s70, v2
  v_mad_u32_u24 v9, s70, v3, v4
  ds_read_b128 v[88:91], v8
  ds_read2_b64 v[84:87], v9 offset0:2 offset1:6
  ds_read2_b32 v[152:153], v8 offset0:6 offset1:6
  s_add_u32 s4, s70, 768
  s_cmp_lt_u32 s4, s84
  s_cselect_b32 s4, s4, 42880
  v_add_u32 v11, s4, v2
  ds_read_b32 v7, v11
  s_add_u32 s70, s70, 256
  s_waitcnt lgkmcnt(3)
  v_readfirstlane_b32 s5, v88
  s_cmp_lt_i32 s5, 0
  s_cbranch_scc0 K2_N1
  s_mov_b32 s72, s5
  v_readlane_b32 s73, v88, 8
  s_cmp_eq_u32 s33, 0
  s_cbranch_scc1 K2_W7_N
  s_cmp_eq_u32 s33, 1
  s_cbranch_scc0 K2_W7_T1
  s_waitcnt vmcnt(5)
  s_branch K2_W7_E
K2_W7_T1:
  s_waitcnt vmcnt(0)
  s_branch K2_W7_E
K2_W7_N:
  s_cmp_eq_u32 s85, 0
  s_cbranch_scc1 K2_W7_0
  s_bcnt1_i32_b32 s4, s85
  s_cmp_eq_u32 s4, 1
  s_cbranch_scc1 K2_W7_1
  s_cmp_eq_u32 s4, 2
  s_cbranch_scc1 K2_W7_2
  s_waitcnt vmcnt(22)
  s_branch K2_W7_E
K2_W7_2:
  s_waitcnt vmcnt(18)
  s_branch K2_W7_E
K2_W7_1:
  s_waitcnt vmcnt(14)
  s_branch K2_W7_E
K2_W7_0:
  s_waitcnt vmcnt(10)
K2_W7_E:
  v_lshl_add_u32 v15, v88, 2, v1
  s_cmp_eq_u32 s27, 0
  s_cbranch_scc1 K2_I01
  v_lshlrev_b32 v8, 1, v15
  buffer_load_dwordx4 v[40:43], v8, s[48:51], 0 offen offset:0 sc0 sc1
  buffer_load_dwordx4 v[44:47], v8, s[48:51], 0 offen offset:16 sc0 sc1
  buffer_load_dwordx4 v[48:51], v8, s[48:51], 0 offen offset:512 sc0 sc1
  buffer_load_dwordx4 v[52:55], v8, s[48:51], 0 offen offset:528 sc0 sc1
  buffer_load_dwordx4 v[56:59], v8, s[48:51], 0 offen offset:1024 sc0 sc1
  buffer_load_dwordx4 v[60:63], v8, s[48:51], 0 offen offset:1040 sc0 sc1
  buffer_load_dwordx4 v[64:67], v8, s[48:51], 0 offen offset:1536 sc0 sc1
  buffer_load_dwordx4 v[68:71], v8, s[48:51], 0 offen offset:1552 sc0 sc1
  s_waitcnt vmcnt(0) lgkmcnt(0)
  s_branch K2_C1
K2_I01:
  v_lshlrev_b32 v40, 16, v112
  v_and_b32 v42, v12, v112
  v_lshlrev_b32 v41, 16, v113
  v_and_b32 v43, v12, v113
  v_lshlrev_b32 v44, 16, v114
  v_and_b32 v46, v12, v114
  v_lshlrev_b32 v45, 16, v115
  v_and_b32 v47, v12, v115
  v_lshlrev_b32 v48, 16, v120
  v_and_b32 v50, v12, v120
  v_lshlrev_b32 v49, 16, v121
  v_and_b32 v51, v12, v121
  v_lshlrev_b32 v52, 16, v122
  v_and_b32 v54, v12, v122
  v_lshlrev_b32 v53, 16, v123
  v_and_b32 v55, v12, v123
  v_lshlrev_b32 v56, 16, v124
  v_and_b32 v58, v12, v124
  v_lshlrev_b32 v57, 16, v125
  v_and_b32 v59, v12, v125
  v_lshlrev_b32 v60, 16, v126
  v_and_b32 v62, v12, v126
  v_lshlrev_b32 v61, 16, v127
  v_and_b32 v63, v12, v127
  v_lshlrev_b32 v64, 16, v128
  v_and_b32 v66, v12, v128
  v_lshlrev_b32 v65, 16, v129
  v_and_b32 v67, v12, v129
  v_lshlrev_b32 v68, 16, v130
  v_and_b32 v70, v12, v130
  v_lshlrev_b32 v69, 16, v131
  v_and_b32 v71, v12, v131
  s_waitcnt lgkmcnt(0)
  s_branch K2_C1
K2_N1:
  s_waitcnt lgkmcnt(2)
  v_mfma_f32_16x16x32_bf16 v[72:75], v[84:87], v[16:19], 0
  v_mfma_f32_16x16x32_bf16 v[76:79], v[84:87], v[24:27], 0
  v_mfma_f32_16x16x32_bf16 v[80:83], v[84:87], v[32:35], 0
  s_cmp_eq_u32 s33, 0
  s_cbranch_scc1 K2_W8_N
  s_cmp_eq_u32 s33, 1
  s_cbranch_scc0 K2_W8_T1
  s_waitcnt vmcnt(5)
  s_branch K2_W8_E
K2_W8_T1:
  s_waitcnt vmcnt(0)
  s_branch K2_W8_E
K2_W8_N:
  s_cmp_eq_u32 s85, 0
  s_cbranch_scc1 K2_W8_0
  s_bcnt1_i32_b32 s4, s85
  s_cmp_eq_u32 s4, 1
  s_cbranch_scc1 K2_W8_1
  s_cmp_eq_u32 s4, 2
  s_cbranch_scc1 K2_W8_2
  s_waitcnt vmcnt(22)
  s_branch K2_W8_E
K2_W8_2:
  s_waitcnt vmcnt(18)
  s_branch K2_W8_E
K2_W8_1:
  s_waitcnt vmcnt(14)
  s_branch K2_W8_E
K2_W8_0:
  s_waitcnt vmcnt(10)
K2_W8_E:
  s_waitcnt lgkmcnt(0)
  v_lshlrev_b32 v8, 16, v116
  v_lshlrev_b32 v9, 16, v117
  v_and_b32 v116, v12, v116
  v_and_b32 v117, v12, v117
  v_lshlrev_b32 v10, 16, v112
  v_lshlrev_b32 v11, 16, v113
  v_and_b32 v112, v12, v112
  v_and_b32 v113, v12, v113
  v_pk_mul_f32 v[80:81], v[80:81], v[8:9]
  v_pk_mul_f32 v[82:83], v[82:83], v[116:117]
  v_pk_mul_f32 v[72:73], v[72:73], v[152:153]
  v_pk_mul_f32 v[74:75], v[74:75], v[152:153]
  v_pk_mul_f32 v[76:77], v[76:77], v[152:153]
  v_pk_mul_f32 v[78:79], v[78:79], v[152:153]
  v_pk_fma_f32 v[40:41], v[72:73], v[10:11], v[40:41]
  v_pk_fma_f32 v[42:43], v[74:75], v[112:113], v[42:43]
  v_lshlrev_b32 v10, 16, v120
  v_lshlrev_b32 v11, 16, v121
  v_and_b32 v120, v12, v120
  v_and_b32 v121, v12, v121
  v_lshlrev_b32 v8, 16, v124
  v_lshlrev_b32 v9, 16, v125
  v_and_b32 v124, v12, v124
  v_and_b32 v125, v12, v125
  v_fmac_f32 v48, v80, v89
  v_fmac_f32 v49, v81, v89
  v_fmac_f32 v50, v82, v89
  v_fmac_f32 v51, v83, v89
  v_pk_fma_f32 v[48:49], v[76:77], v[10:11], v[48:49]
  v_pk_fma_f32 v[50:51], v[78:79], v[120:121], v[50:51]
  v_lshlrev_b32 v10, 16, v128
  v_lshlrev_b32 v11, 16, v129
  v_and_b32 v128, v12, v128
  v_and_b32 v129, v12, v129
  v_fmac_f32 v56, v80, v90
  v_fmac_f32 v57, v81, v90
  v_fmac_f32 v58, v82, v90
  v_fmac_f32 v59, v83, v90
  v_pk_fma_f32 v[56:57], v[76:77], v[8:9], v[56:57]
  v_pk_fma_f32 v[58:59], v[78:79], v[124:125], v[58:59]
  v_fmac_f32 v64, v80, v91
  v_fmac_f32 v65, v81, v91
  v_fmac_f32 v66, v82, v91
  v_fmac_f32 v67, v83, v91
  v_pk_fma_f32 v[64:65], v[76:77], v[10:11], v[64:65]
  v_pk_fma_f32 v[66:67], v[78:79], v[128:129], v[66:67]
  v_mfma_f32_16x16x32_bf16 v[72:75], v[84:87], v[20:23], 0
  v_mfma_f32_16x16x32_bf16 v[76:79], v[84:87], v[28:31], 0
  v_mfma_f32_16x16x32_bf16 v[80:83], v[84:87], v[36:39], 0
  v_lshlrev_b32 v8, 16, v118
  v_lshlrev_b32 v9, 16, v119
  v_and_b32 v118, v12, v118
  v_and_b32 v119, v12, v119
  v_lshlrev_b32 v10, 16, v114
  v_lshlrev_b32 v11, 16, v115
  v_and_b32 v114, v12, v114
  v_and_b32 v115, v12, v115
  v_pk_mul_f32 v[80:81], v[80:81], v[8:9]
  v_pk_mul_f32 v[82:83], v[82:83], v[118:119]
  v_pk_mul_f32 v[72:73], v[72:73], v[152:153]
  v_pk_mul_f32 v[74:75], v[74:75], v[152:153]
  v_pk_mul_f32 v[76:77], v[76:77], v[152:153]
  v_pk_mul_f32 v[78:79], v[78:79], v[152:153]
  v_pk_fma_f32 v[44:45], v[72:73], v[10:11], v[44:45]
  v_pk_fma_f32 v[46:47], v[74:75], v[114:115], v[46:47]
  v_lshlrev_b32 v10, 16, v122
  v_lshlrev_b32 v11, 16, v123
  v_and_b32 v122, v12, v122
  v_and_b32 v123, v12, v123
  v_lshlrev_b32 v8, 16, v126
  v_lshlrev_b32 v9, 16, v127
  v_and_b32 v126, v12, v126
  v_and_b32 v127, v12, v127
  v_fmac_f32 v52, v80, v89
  v_fmac_f32 v53, v81, v89
  v_fmac_f32 v54, v82, v89
  v_fmac_f32 v55, v83, v89
  v_pk_fma_f32 v[52:53], v[76:77], v[10:11], v[52:53]
  v_pk_fma_f32 v[54:55], v[78:79], v[122:123], v[54:55]
  v_lshlrev_b32 v10, 16, v130
  v_lshlrev_b32 v11, 16, v131
  v_and_b32 v130, v12, v130
  v_and_b32 v131, v12, v131
  v_fmac_f32 v60, v80, v90
  v_fmac_f32 v61, v81, v90
  v_fmac_f32 v62, v82, v90
  v_fmac_f32 v63, v83, v90
  v_pk_fma_f32 v[60:61], v[76:77], v[8:9], v[60:61]
  v_pk_fma_f32 v[62:63], v[78:79], v[126:127], v[62:63]
  v_fmac_f32 v68, v80, v91
  v_fmac_f32 v69, v81, v91
  v_fmac_f32 v70, v82, v91
  v_fmac_f32 v71, v83, v91
  v_pk_fma_f32 v[68:69], v[76:77], v[10:11], v[68:69]
  v_pk_fma_f32 v[70:71], v[78:79], v[130:131], v[70:71]
K2_C1:
  s_add_u32 s4, s70, 512
  s_cmp_lt_u32 s4, s84
  s_cbranch_scc1 K2_IR9
  s_add_u32 s33, s33, 1
  s_branch K2_IE9
K2_IR9:
  v_readfirstlane_b32 s4, v7
  v_mad_u32_u24 v8, v7, 5, v1
  s_cmp_lt_i32 s4, 0
  s_cbranch_scc1 K2_II9
  v_cmp_ne_u32 vcc, 0xffff00, v7
  s_or_b32 vcc_lo, vcc_lo, 1
  s_mov_b64 exec, vcc
  buffer_load_dwordx4 v[112:115], v8, s[40:43], 0 offen offset:0
  buffer_load_dwordx4 v[116:119], v8, s[40:43], 0 offen offset:256
  buffer_load_dwordx4 v[120:123], v8, s[40:43], 0 offen offset:512
  buffer_load_dwordx4 v[124:127], v8, s[40:43], 0 offen offset:768
  buffer_load_dwordx4 v[128:131], v8, s[40:43], 0 offen offset:1024
  s_mov_b64 exec, -1
  s_branch K2_IE9
K2_II9:
  v_lshl_add_u32 v9, v7, 2, v1
  v_mov_b32 v8, 0xfffff000
  buffer_load_dwordx4 v[112:115], v9, s[60:63], 0 offen
  buffer_load_dwordx4 v[120:123], v9, s[60:63], 0 offen offset:256
  buffer_load_dwordx4 v[124:127], v9, s[60:63], 0 offen offset:512
  buffer_load_dwordx4 v[128:131], v9, s[60:63], 0 offen offset:768
  s_mov_b64 exec, 1
  buffer_load_dword v116, v8, s[40:43], 0 offen
  s_mov_b64 exec, -1
K2_IE9:
  s_lshl_b32 s85, s85, 1
  s_and_b32 s85, s85, 7
  s_cmp_lt_u32 s70, s71
  s_cbranch_scc1 K2_G2
  s_ff1_i32_b64 s69, s[82:83]
  s_max_i32 s69, s69, 0
  v_readlane_b32 s5, v5, s69
  s_bitset0_b64 s[82:83], s69
  s_bitcmp1_b32 s72, 30
  s_cbranch_scc1 K2_FW1
  s_or_b32 s85, s85, 1
  s_cmp_eq_u32 s26, 0
  s_cbranch_scc1 K2_F01
  v_lshlrev_b32 v8, 1, v15
  buffer_store_dwordx4 v[40:43], v8, s[48:51], 0 offen offset:0
  buffer_store_dwordx4 v[44:47], v8, s[48:51], 0 offen offset:16
  buffer_store_dwordx4 v[48:51], v8, s[48:51], 0 offen offset:512
  buffer_store_dwordx4 v[52:55], v8, s[48:51], 0 offen offset:528
  buffer_store_dwordx4 v[56:59], v8, s[48:51], 0 offen offset:1024
  buffer_store_dwordx4 v[60:63], v8, s[48:51], 0 offen offset:1040
  buffer_store_dwordx4 v[64:67], v8, s[48:51], 0 offen offset:1536
  buffer_store_dwordx4 v[68:71], v8, s[48:51], 0 offen offset:1552
K2_F01:
  v_cvt_pk_bf16_f32 v72, v40, v42
  v_cvt_pk_bf16_f32 v73, v41, v43
  v_cvt_pk_bf16_f32 v74, v44, v46
  v_cvt_pk_bf16_f32 v75, v45, v47
  buffer_store_dwordx4 v[72:75], v15, s[44:47], 0 offen offset:0 sc1
  v_cvt_pk_bf16_f32 v76, v48, v50
  v_cvt_pk_bf16_f32 v77, v49, v51
  v_cvt_pk_bf16_f32 v78, v52, v54
  v_cvt_pk_bf16_f32 v79, v53, v55
  buffer_store_dwordx4 v[76:79], v15, s[44:47], 0 offen offset:256 sc1
  v_cvt_pk_bf16_f32 v80, v56, v58
  v_cvt_pk_bf16_f32 v81, v57, v59
  v_cvt_pk_bf16_f32 v82, v60, v62
  v_cvt_pk_bf16_f32 v83, v61, v63
  buffer_store_dwordx4 v[80:83], v15, s[44:47], 0 offen offset:512 sc1
  v_cvt_pk_bf16_f32 v84, v64, v66
  v_cvt_pk_bf16_f32 v85, v65, v67
  v_cvt_pk_bf16_f32 v86, v68, v70
  v_cvt_pk_bf16_f32 v87, v69, v71
  buffer_store_dwordx4 v[84:87], v15, s[44:47], 0 offen offset:768 sc1
  s_branch K2_FE1
K2_FW1:
  v_permlane32_swap_b32 v40, v56
  v_permlane32_swap_b32 v41, v57
  v_permlane32_swap_b32 v42, v58
  v_permlane32_swap_b32 v43, v59
  v_permlane32_swap_b32 v44, v60
  v_permlane32_swap_b32 v45, v61
  v_permlane32_swap_b32 v46, v62
  v_permlane32_swap_b32 v47, v63
  v_permlane32_swap_b32 v48, v64
  v_permlane32_swap_b32 v49, v65
  v_permlane32_swap_b32 v50, v66
  v_permlane32_swap_b32 v51, v67
  v_permlane32_swap_b32 v52, v68
  v_permlane32_swap_b32 v53, v69
  v_permlane32_swap_b32 v54, v70
  v_permlane32_swap_b32 v55, v71
  s_lshl_b32 s4, s72, 2
  s_lshl_b32 s6, s73, 2
  v_mov_b32 v10, s4
  v_mov_b32 v9, s6
  v_cndmask_b32 v10, v10, v9, s[28:29]
  v_and_b32 v11, 0xc0, v2
  v_lshl_add_u32 v11, v11, 2, v1
  v_pk_add_f32 v[40:41], v[40:41], v[56:57]
  v_pk_add_f32 v[42:43], v[42:43], v[58:59]
  v_pk_add_f32 v[44:45], v[44:45], v[60:61]
  v_pk_add_f32 v[46:47], v[46:47], v[62:63]
  v_pk_add_f32 v[48:49], v[48:49], v[64:65]
  v_pk_add_f32 v[50:51], v[50:51], v[66:67]
  v_pk_add_f32 v[52:53], v[52:53], v[68:69]
  v_pk_add_f32 v[54:55], v[54:55], v[70:71]
  v_permlane16_swap_b32 v40, v48
  v_permlane16_swap_b32 v41, v49
  v_permlane16_swap_b32 v42, v50
  v_permlane16_swap_b32 v43, v51
  v_permlane16_swap_b32 v44, v52
  v_permlane16_swap_b32 v45, v53
  v_permlane16_swap_b32 v46, v54
  v_permlane16_swap_b32 v47, v55
  v_add_u32 v11, v10, v11
  v_pk_add_f32 v[40:41], v[40:41], v[48:49]
  v_pk_add_f32 v[42:43], v[42:43], v[50:51]
  v_pk_add_f32 v[44:45], v[44:45], v[52:53]
  v_pk_add_f32 v[46:47], v[46:47], v[54:55]
  v_cvt_pk_bf16_f32 v72, v40, v42
  v_cvt_pk_bf16_f32 v73, v41, v43
  v_cvt_pk_bf16_f32 v74, v44, v46
  v_cvt_pk_bf16_f32 v75, v45, v47
  buffer_store_dwordx4 v[72:75], v11, s[44:47], 0 offen sc1
  s_cmp_eq_u32 s26, 0
  s_cbranch_scc1 K2_FE1
  v_lshlrev_b32 v8, 1, v11
  buffer_store_dwordx4 v[40:43], v8, s[48:51], 0 offen offset:0
  buffer_store_dwordx4 v[44:47], v8, s[48:51], 0 offen offset:16
K2_FE1:
  s_lshr_b32 s5, s5, 16
  s_add_u32 s71, s71, s5
  s_cmp_lt_u32 s70, s84
  s_cbranch_scc1 K2_G2
  s_branch K2_QDONE
K2_G2:
  v_add_u32 v8, s70, v2
  v_mad_u32_u24 v9, s70, v3, v4
  ds_read_b128 v[88:91], v8
  ds_read2_b64 v[84:87], v9 offset0:2 offset1:6
  ds_read2_b32 v[152:153], v8 offset0:6 offset1:6
  s_add_u32 s4, s70, 768
  s_cmp_lt_u32 s4, s84
  s_cselect_b32 s4, s4, 42880
  v_add_u32 v11, s4, v2
  ds_read_b32 v7, v11
  s_add_u32 s70, s70, 256
  s_waitcnt lgkmcnt(3)
  v_readfirstlane_b32 s5, v88
  s_cmp_lt_i32 s5, 0
  s_cbranch_scc0 K2_N2
  s_mov_b32 s72, s5
  v_readlane_b32 s73, v88, 8
  s_cmp_eq_u32 s33, 0
  s_cbranch_scc1 K2_W10_N
  s_cmp_eq_u32 s33, 1
  s_cbranch_scc0 K2_W10_T1
  s_waitcnt vmcnt(5)
  s_branch K2_W10_E
K2_W10_T1:
  s_waitcnt vmcnt(0)
  s_branch K2_W10_E
K2_W10_N:
  s_cmp_eq_u32 s85, 0
  s_cbranch_scc1 K2_W10_0
  s_bcnt1_i32_b32 s4, s85
  s_cmp_eq_u32 s4, 1
  s_cbranch_scc1 K2_W10_1
  s_cmp_eq_u32 s4, 2
  s_cbranch_scc1 K2_W10_2
  s_waitcnt vmcnt(22)
  s_branch K2_W10_E
K2_W10_2:
  s_waitcnt vmcnt(18)
  s_branch K2_W10_E
K2_W10_1:
  s_waitcnt vmcnt(14)
  s_branch K2_W10_E
K2_W10_0:
  s_waitcnt vmcnt(10)
K2_W10_E:
  v_lshl_add_u32 v15, v88, 2, v1
  s_cmp_eq_u32 s27, 0
  s_cbranch_scc1 K2_I02
  v_lshlrev_b32 v8, 1, v15
  buffer_load_dwordx4 v[40:43], v8, s[48:51], 0 offen offset:0 sc0 sc1
  buffer_load_dwordx4 v[44:47], v8, s[48:51], 0 offen offset:16 sc0 sc1
  buffer_load_dwordx4 v[48:51], v8, s[48:51], 0 offen offset:512 sc0 sc1
  buffer_load_dwordx4 v[52:55], v8, s[48:51], 0 offen offset:528 sc0 sc1
  buffer_load_dwordx4 v[56:59], v8, s[48:51], 0 offen offset:1024 sc0 sc1
  buffer_load_dwordx4 v[60:63], v8, s[48:51], 0 offen offset:1040 sc0 sc1
  buffer_load_dwordx4 v[64:67], v8, s[48:51], 0 offen offset:1536 sc0 sc1
  buffer_load_dwordx4 v[68:71], v8, s[48:51], 0 offen offset:1552 sc0 sc1
  s_waitcnt vmcnt(0) lgkmcnt(0)
  s_branch K2_C2
K2_I02:
  v_lshlrev_b32 v40, 16, v132
  v_and_b32 v42, v12, v132
  v_lshlrev_b32 v41, 16, v133
  v_and_b32 v43, v12, v133
  v_lshlrev_b32 v44, 16, v134
  v_and_b32 v46, v12, v134
  v_lshlrev_b32 v45, 16, v135
  v_and_b32 v47, v12, v135
  v_lshlrev_b32 v48, 16, v140
  v_and_b32 v50, v12, v140
  v_lshlrev_b32 v49, 16, v141
  v_and_b32 v51, v12, v141
  v_lshlrev_b32 v52, 16, v142
  v_and_b32 v54, v12, v142
  v_lshlrev_b32 v53, 16, v143
  v_and_b32 v55, v12, v143
  v_lshlrev_b32 v56, 16, v144
  v_and_b32 v58, v12, v144
  v_lshlrev_b32 v57, 16, v145
  v_and_b32 v59, v12, v145
  v_lshlrev_b32 v60, 16, v146
  v_and_b32 v62, v12, v146
  v_lshlrev_b32 v61, 16, v147
  v_and_b32 v63, v12, v147
  v_lshlrev_b32 v64, 16, v148
  v_and_b32 v66, v12, v148
  v_lshlrev_b32 v65, 16, v149
  v_and_b32 v67, v12, v149
  v_lshlrev_b32 v68, 16, v150
  v_and_b32 v70, v12, v150
  v_lshlrev_b32 v69, 16, v151
  v_and_b32 v71, v12, v151
  s_waitcnt lgkmcnt(0)
  s_branch K2_C2
K2_N2:
  s_waitcnt lgkmcnt(2)
  v_mfma_f32_16x16x32_bf16 v[72:75], v[84:87], v[16:19], 0
  v_mfma_f32_16x16x32_bf16 v[76:79], v[84:87], v[24:27], 0
  v_mfma_f32_16x16x32_bf16 v[80:83], v[84:87], v[32:35], 0
  s_cmp_eq_u32 s33, 0
  s_cbranch_scc1 K2_W11_N
  s_cmp_eq_u32 s33, 1
  s_cbranch_scc0 K2_W11_T1
  s_waitcnt vmcnt(5)
  s_branch K2_W11_E
K2_W11_T1:
  s_waitcnt vmcnt(0)
  s_branch K2_W11_E
K2_W11_N:
  s_cmp_eq_u32 s85, 0
  s_cbranch_scc1 K2_W11_0
  s_bcnt1_i32_b32 s4, s85
  s_cmp_eq_u32 s4, 1
  s_cbranch_scc1 K2_W11_1
  s_cmp_eq_u32 s4, 2
  s_cbranch_scc1 K2_W11_2
  s_waitcnt vmcnt(22)
  s_branch K2_W11_E
K2_W11_2:
  s_waitcnt vmcnt(18)
  s_branch K2_W11_E
K2_W11_1:
  s_waitcnt vmcnt(14)
  s_branch K2_W11_E
K2_W11_0:
  s_waitcnt vmcnt(10)
K2_W11_E:
  s_waitcnt lgkmcnt(0)
  v_lshlrev_b32 v8, 16, v136
  v_lshlrev_b32 v9, 16, v137
  v_and_b32 v136, v12, v136
  v_and_b32 v137, v12, v137
  v_lshlrev_b32 v10, 16, v132
  v_lshlrev_b32 v11, 16, v133
  v_and_b32 v132, v12, v132
  v_and_b32 v133, v12, v133
  v_pk_mul_f32 v[80:81], v[80:81], v[8:9]
  v_pk_mul_f32 v[82:83], v[82:83], v[136:137]
  v_pk_mul_f32 v[72:73], v[72:73], v[152:153]
  v_pk_mul_f32 v[74:75], v[74:75], v[152:153]
  v_pk_mul_f32 v[76:77], v[76:77], v[152:153]
  v_pk_mul_f32 v[78:79], v[78:79], v[152:153]
  v_pk_fma_f32 v[40:41], v[72:73], v[10:11], v[40:41]
  v_pk_fma_f32 v[42:43], v[74:75], v[132:133], v[42:43]
  v_lshlrev_b32 v10, 16, v140
  v_lshlrev_b32 v11, 16, v141
  v_and_b32 v140, v12, v140
  v_and_b32 v141, v12, v141
  v_lshlrev_b32 v8, 16, v144
  v_lshlrev_b32 v9, 16, v145
  v_and_b32 v144, v12, v144
  v_and_b32 v145, v12, v145
  v_fmac_f32 v48, v80, v89
  v_fmac_f32 v49, v81, v89
  v_fmac_f32 v50, v82, v89
  v_fmac_f32 v51, v83, v89
  v_pk_fma_f32 v[48:49], v[76:77], v[10:11], v[48:49]
  v_pk_fma_f32 v[50:51], v[78:79], v[140:141], v[50:51]
  v_lshlrev_b32 v10, 16, v148
  v_lshlrev_b32 v11, 16, v149
  v_and_b32 v148, v12, v148
  v_and_b32 v149, v12, v149
  v_fmac_f32 v56, v80, v90
  v_fmac_f32 v57, v81, v90
  v_fmac_f32 v58, v82, v90
  v_fmac_f32 v59, v83, v90
  v_pk_fma_f32 v[56:57], v[76:77], v[8:9], v[56:57]
  v_pk_fma_f32 v[58:59], v[78:79], v[144:145], v[58:59]
  v_fmac_f32 v64, v80, v91
  v_fmac_f32 v65, v81, v91
  v_fmac_f32 v66, v82, v91
  v_fmac_f32 v67, v83, v91
  v_pk_fma_f32 v[64:65], v[76:77], v[10:11], v[64:65]
  v_pk_fma_f32 v[66:67], v[78:79], v[148:149], v[66:67]
  v_mfma_f32_16x16x32_bf16 v[72:75], v[84:87], v[20:23], 0
  v_mfma_f32_16x16x32_bf16 v[76:79], v[84:87], v[28:31], 0
  v_mfma_f32_16x16x32_bf16 v[80:83], v[84:87], v[36:39], 0
  v_lshlrev_b32 v8, 16, v138
  v_lshlrev_b32 v9, 16, v139
  v_and_b32 v138, v12, v138
  v_and_b32 v139, v12, v139
  v_lshlrev_b32 v10, 16, v134
  v_lshlrev_b32 v11, 16, v135
  v_and_b32 v134, v12, v134
  v_and_b32 v135, v12, v135
  v_pk_mul_f32 v[80:81], v[80:81], v[8:9]
  v_pk_mul_f32 v[82:83], v[82:83], v[138:139]
  v_pk_mul_f32 v[72:73], v[72:73], v[152:153]
  v_pk_mul_f32 v[74:75], v[74:75], v[152:153]
  v_pk_mul_f32 v[76:77], v[76:77], v[152:153]
  v_pk_mul_f32 v[78:79], v[78:79], v[152:153]
  v_pk_fma_f32 v[44:45], v[72:73], v[10:11], v[44:45]
  v_pk_fma_f32 v[46:47], v[74:75], v[134:135], v[46:47]
  v_lshlrev_b32 v10, 16, v142
  v_lshlrev_b32 v11, 16, v143
  v_and_b32 v142, v12, v142
  v_and_b32 v143, v12, v143
  v_lshlrev_b32 v8, 16, v146
  v_lshlrev_b32 v9, 16, v147
  v_and_b32 v146, v12, v146
  v_and_b32 v147, v12, v147
  v_fmac_f32 v52, v80, v89
  v_fmac_f32 v53, v81, v89
  v_fmac_f32 v54, v82, v89
  v_fmac_f32 v55, v83, v89
  v_pk_fma_f32 v[52:53], v[76:77], v[10:11], v[52:53]
  v_pk_fma_f32 v[54:55], v[78:79], v[142:143], v[54:55]
  v_lshlrev_b32 v10, 16, v150
  v_lshlrev_b32 v11, 16, v151
  v_and_b32 v150, v12, v150
  v_and_b32 v151, v12, v151
  v_fmac_f32 v60, v80, v90
  v_fmac_f32 v61, v81, v90
  v_fmac_f32 v62, v82, v90
  v_fmac_f32 v63, v83, v90
  v_pk_fma_f32 v[60:61], v[76:77], v[8:9], v[60:61]
  v_pk_fma_f32 v[62:63], v[78:79], v[146:147], v[62:63]
  v_fmac_f32 v68, v80, v91
  v_fmac_f32 v69, v81, v91
  v_fmac_f32 v70, v82, v91
  v_fmac_f32 v71, v83, v91
  v_pk_fma_f32 v[68:69], v[76:77], v[10:11], v[68:69]
  v_pk_fma_f32 v[70:71], v[78:79], v[150:151], v[70:71]
K2_C2:
  s_add_u32 s4, s70, 512
  s_cmp_lt_u32 s4, s84
  s_cbranch_scc1 K2_IR12
  s_add_u32 s33, s33, 1
  s_branch K2_IE12
K2_IR12:
  v_readfirstlane_b32 s4, v7
  v_mad_u32_u24 v8, v7, 5, v1
  s_cmp_lt_i32 s4, 0
  s_cbranch_scc1 K2_II12
  v_cmp_ne_u32 vcc, 0xffff00, v7
  s_or_b32 vcc_lo, vcc_lo, 1
  s_mov_b64 exec, vcc
  buffer_load_dwordx4 v[132:135], v8, s[40:43], 0 offen offset:0
  buffer_load_dwordx4 v[136:139], v8, s[40:43], 0 offen offset:256
  buffer_load_dwordx4 v[140:143], v8, s[40:43], 0 offen offset:512
  buffer_load_dwordx4 v[144:147], v8, s[40:43], 0 offen offset:768
  buffer_load_dwordx4 v[148:151], v8, s[40:43], 0 offen offset:1024
  s_mov_b64 exec, -1
  s_branch K2_IE12
K2_II12:
  v_lshl_add_u32 v9, v7, 2, v1
  v_mov_b32 v8, 0xfffff000
  buffer_load_dwordx4 v[132:135], v9, s[60:63], 0 offen
  buffer_load_dwordx4 v[140:143], v9, s[60:63], 0 offen offset:256
  buffer_load_dwordx4 v[144:147], v9, s[60:63], 0 offen offset:512
  buffer_load_dwordx4 v[148:151], v9, s[60:63], 0 offen offset:768
  s_mov_b64 exec, 1
  buffer_load_dword v136, v8, s[40:43], 0 offen
  s_mov_b64 exec, -1
K2_IE12:
  s_lshl_b32 s85, s85, 1
  s_and_b32 s85, s85, 7
  s_cmp_lt_u32 s70, s71
  s_cbranch_scc1 K2_G0
  s_ff1_i32_b64 s69, s[82:83]
  s_max_i32 s69, s69, 0
  v_readlane_b32 s5, v5, s69
  s_bitset0_b64 s[82:83], s69
  s_bitcmp1_b32 s72, 30
  s_cbranch_scc1 K2_FW2
  s_or_b32 s85, s85, 1
  s_cmp_eq_u32 s26, 0
  s_cbranch_scc1 K2_F02
  v_lshlrev_b32 v8, 1, v15
  buffer_store_dwordx4 v[40:43], v8, s[48:51], 0 offen offset:0
  buffer_store_dwordx4 v[44:47], v8, s[48:51], 0 offen offset:16
  buffer_store_dwordx4 v[48:51], v8, s[48:51], 0 offen offset:512
  buffer_store_dwordx4 v[52:55], v8, s[48:51], 0 offen offset:528
  buffer_store_dwordx4 v[56:59], v8, s[48:51], 0 offen offset:1024
  buffer_store_dwordx4 v[60:63], v8, s[48:51], 0 offen offset:1040
  buffer_store_dwordx4 v[64:67], v8, s[48:51], 0 offen offset:1536
  buffer_store_dwordx4 v[68:71], v8, s[48:51], 0 offen offset:1552
K2_F02:
  v_cvt_pk_bf16_f32 v72, v40, v42
  v_cvt_pk_bf16_f32 v73, v41, v43
  v_cvt_pk_bf16_f32 v74, v44, v46
  v_cvt_pk_bf16_f32 v75, v45, v47
  buffer_store_dwordx4 v[72:75], v15, s[44:47], 0 offen offset:0 sc1
  v_cvt_pk_bf16_f32 v76, v48, v50
  v_cvt_pk_bf16_f32 v77, v49, v51
  v_cvt_pk_bf16_f32 v78, v52, v54
  v_cvt_pk_bf16_f32 v79, v53, v55
  buffer_store_dwordx4 v[76:79], v15, s[44:47], 0 offen offset:256 sc1
  v_cvt_pk_bf16_f32 v80, v56, v58
  v_cvt_pk_bf16_f32 v81, v57, v59
  v_cvt_pk_bf16_f32 v82, v60, v62
  v_cvt_pk_bf16_f32 v83, v61, v63
  buffer_store_dwordx4 v[80:83], v15, s[44:47], 0 offen offset:512 sc1
  v_cvt_pk_bf16_f32 v84, v64, v66
  v_cvt_pk_bf16_f32 v85, v65, v67
  v_cvt_pk_bf16_f32 v86, v68, v70
  v_cvt_pk_bf16_f32 v87, v69, v71
  buffer_store_dwordx4 v[84:87], v15, s[44:47], 0 offen offset:768 sc1
  s_branch K2_FE2
K2_FW2:
  v_permlane32_swap_b32 v40, v56
  v_permlane32_swap_b32 v41, v57
  v_permlane32_swap_b32 v42, v58
  v_permlane32_swap_b32 v43, v59
  v_permlane32_swap_b32 v44, v60
  v_permlane32_swap_b32 v45, v61
  v_permlane32_swap_b32 v46, v62
  v_permlane32_swap_b32 v47, v63
  v_permlane32_swap_b32 v48, v64
  v_permlane32_swap_b32 v49, v65
  v_permlane32_swap_b32 v50, v66
  v_permlane32_swap_b32 v51, v67
  v_permlane32_swap_b32 v52, v68
  v_permlane32_swap_b32 v53, v69
  v_permlane32_swap_b32 v54, v70
  v_permlane32_swap_b32 v55, v71
  s_lshl_b32 s4, s72, 2
  s_lshl_b32 s6, s73, 2
  v_mov_b32 v10, s4
  v_mov_b32 v9, s6
  v_cndmask_b32 v10, v10, v9, s[28:29]
  v_and_b32 v11, 0xc0, v2
  v_lshl_add_u32 v11, v11, 2, v1
  v_pk_add_f32 v[40:41], v[40:41], v[56:57]
  v_pk_add_f32 v[42:43], v[42:43], v[58:59]
  v_pk_add_f32 v[44:45], v[44:45], v[60:61]
  v_pk_add_f32 v[46:47], v[46:47], v[62:63]
  v_pk_add_f32 v[48:49], v[48:49], v[64:65]
  v_pk_add_f32 v[50:51], v[50:51], v[66:67]
  v_pk_add_f32 v[52:53], v[52:53], v[68:69]
  v_pk_add_f32 v[54:55], v[54:55], v[70:71]
  v_permlane16_swap_b32 v40, v48
  v_permlane16_swap_b32 v41, v49
  v_permlane16_swap_b32 v42, v50
  v_permlane16_swap_b32 v43, v51
  v_permlane16_swap_b32 v44, v52
  v_permlane16_swap_b32 v45, v53
  v_permlane16_swap_b32 v46, v54
  v_permlane16_swap_b32 v47, v55
  v_add_u32 v11, v10, v11
  v_pk_add_f32 v[40:41], v[40:41], v[48:49]
  v_pk_add_f32 v[42:43], v[42:43], v[50:51]
  v_pk_add_f32 v[44:45], v[44:45], v[52:53]
  v_pk_add_f32 v[46:47], v[46:47], v[54:55]
  v_cvt_pk_bf16_f32 v72, v40, v42
  v_cvt_pk_bf16_f32 v73, v41, v43
  v_cvt_pk_bf16_f32 v74, v44, v46
  v_cvt_pk_bf16_f32 v75, v45, v47
  buffer_store_dwordx4 v[72:75], v11, s[44:47], 0 offen sc1
  s_cmp_eq_u32 s26, 0
  s_cbranch_scc1 K2_FE2
  v_lshlrev_b32 v8, 1, v11
  buffer_store_dwordx4 v[40:43], v8, s[48:51], 0 offen offset:0
  buffer_store_dwordx4 v[44:47], v8, s[48:51], 0 offen offset:16
K2_FE2:
  s_lshr_b32 s5, s5, 16
  s_add_u32 s71, s71, s5
  s_cmp_lt_u32 s70, s84
  s_cbranch_scc1 K2_G0
  s_branch K2_QDONE
K2_QDONE:
  s_cmp_lg_u32 s64, 0
  s_cbranch_scc1 K2_AGAIN
  s_add_u32 s68, s68, s57
  s_cmp_lg_u32 s26, 0
  s_cbranch_scc1 K2_AGAIN
  s_add_u32 s12, s12, 60
  s_cmp_ge_u32 s12, s15
  s_cbranch_scc1 K2_FIN
  s_mov_b32 s68, 0
K2_AGAIN:
  s_waitcnt vmcnt(0)
  s_barrier
  s_branch K2_ROUND
K2_FIN:
K2_END:
  s_endpgm
.section .rodata,"a"
.p2align 6
.amdhsa_kernel painn_k1_kernel
  .amdhsa_next_free_vgpr 128
  .amdhsa_next_free_sgpr 100
  .amdhsa_accum_offset 128
  .amdhsa_group_segment_fixed_size 0
  .amdhsa_kernarg_size 88
  .amdhsa_user_sgpr_count 2
  .amdhsa_user_sgpr_kernarg_segment_ptr 1
  .amdhsa_system_sgpr_workgroup_id_x 1
.end_amdhsa_kernel
.p2align 6
.amdhsa_kernel painn_k2_kernel
  .amdhsa_next_free_vgpr 156
  .amdhsa_next_free_sgpr 102
  .amdhsa_accum_offset 156
  .amdhsa_group_segment_fixed_size 0
  .amdhsa_kernarg_size 88
  .amdhsa_user_sgpr_count 2
  .amdhsa_user_sgpr_kernarg_segment_ptr 1
  .amdhsa_system_sgpr_workgroup_id_x 1
.end_amdhsa_kernel
```
